```python
import torch

def _softmax(x, axis=-1):
    return torch.softmax(x, dim=axis)
def _gelu(x):
    return torch.nn.functional.gelu(x, approximate="tanh")
def _silu(x):
    return torch.nn.functional.silu(x)
def _sigmoid(x):
    return torch.sigmoid(x)
def _layernorm(x, axis=-1, eps=1e-5):
    m = x.mean(dim=axis, keepdim=True)
    v = x.var(dim=axis, keepdim=True, unbiased=False)
    return (x - m) / torch.sqrt(v + eps)
def _scatter_add(tgt, idx, src, axis=0):
    return tgt.clone().index_add_(axis, idx, src)
def _segment_sum(src, seg, n):
    out = torch.zeros((n,) + src.shape[1:], dtype=src.dtype)
    return out.index_add_(0, seg, src)
def _pad(x, pw):
    flat = tuple(v for pair in reversed(pw) for v in pair)
    return torch.nn.functional.pad(x, flat)

kernel_name = 'parallel_sum__softmax_full_mha__swiglu_ffn__prompt'

def setup_inputs():

    _w = (lambda a: (lambda t: t.to(torch.bfloat16) if t.is_floating_point() else t)(torch.as_tensor(a)))
    def _A_setup():
        B, S, D = 1, 2048, 640
        return {
            "x": _w((lambda *s: torch.randn(*s, dtype=torch.bfloat16) * 0.05)(B, S, D)),
            "wqkv": _w((lambda *s: torch.randn(*s, dtype=torch.bfloat16) * 0.2)(D, 3 * D)),
            "wo": _w((lambda *s: torch.randn(*s, dtype=torch.bfloat16) * 0.1)(D, D)),
        }
    _A_in = _A_setup()

    def _B_setup():
        B, S, D, F = 1, 2048, 640, 1536
        return {
            "x": _w((lambda *s: torch.randn(*s, dtype=torch.bfloat16) * 0.05)(B, S, D)),
            "w_gate": _w((lambda *s: torch.randn(*s, dtype=torch.bfloat16) * 0.1)(D, F)),
            "w_up": _w((lambda *s: torch.randn(*s, dtype=torch.bfloat16) * 0.1)(D, F)),
            "w_down": _w((lambda *s: torch.randn(*s, dtype=torch.bfloat16) * 0.1)(F, D)),
        }
    _B_in = _B_setup()

    return {
        "A_x": _A_in["x"],
        "A_wqkv": _A_in["wqkv"],
        "A_wo": _A_in["wo"],
        "B_x": _B_in["x"],
        "B_w_gate": _B_in["w_gate"],
        "B_w_up": _B_in["w_up"],
        "B_w_down": _B_in["w_down"],
    }

def reference(A_x, A_wqkv, A_wo, B_x, B_w_gate, B_w_up, B_w_down):
    def _A_ref(x, wqkv, wo):
        B, S, D = x.shape
        H = 32; Dh = D // H
        qkv = (lambda x, *d: x.permute(*d))((x @ wqkv).reshape(B, S, 3, H, Dh), 2, 0, 3, 1, 4)
        q, k, v = qkv[0], qkv[1], qkv[2]
        scale = Dh ** -0.5
        scores = torch.einsum("bhqd,bhkd->bhqk", q, k) * scale
        p = _softmax(scores, axis=-1)
        o = torch.einsum("bhqk,bhkd->bhqd", p, v)
        return (lambda x, *d: x.permute(*d))(o, 0, 2, 1, 3).reshape(B, S, D) @ wo

    def _B_ref(x, w_gate, w_up, w_down):
        g = _silu(x @ w_gate)
        u = x @ w_up
        return (g * u) @ w_down

    x = A_x
    xn = _layernorm(x, axis=-1)
    return x + _A_ref(xn, A_wqkv, A_wo) + _B_ref(xn, B_w_gate, B_w_up, B_w_down)
```

```asm
; @launch grid=(512,1,1) block=(512,1,1) lds=81920
.amdgcn_target "amdgcn-amd-amdhsa--gfx950"
.text
.globl parallel_sum__softmax_full_mha__swiglu_ffn__prompt_kernel
.p2align 8
.type parallel_sum__softmax_full_mha__swiglu_ffn__prompt_kernel,@function
parallel_sum__softmax_full_mha__swiglu_ffn__prompt_kernel:
    s_cmp_ge_u32 s2, 512
    s_cbranch_scc1 L_end
    s_load_dwordx16 s[4:19], s[0:1], 0
    s_load_dwordx4 s[20:23], s[0:1], 64
    v_lshrrev_b32 v1, 6, v0
    v_and_b32 v2, 63, v0
    v_lshlrev_b32 v9, 4, v2
    v_readfirstlane_b32 s25, v1
    s_waitcnt lgkmcnt(0)
    s_mov_b32 s32, s22
    s_mov_b32 s33, s23
    s_mov_b32 s34, 41943040
    s_mov_b32 s35, 0x00020000
    s_cmp_ge_u32 s2, 256
    s_cbranch_scc1 L_roleB
    s_cmp_ge_u32 s25, 2
    s_cbranch_scc1 L_a_noln
    s_lshl_b32 s3, s2, 3
    v_lshrrev_b32 v3, 4, v0
    v_add_u32 v3, s3, v3
    v_mul_u32_u24 v3, 1280, v3
    v_and_b32 v4, 15, v0
    v_lshl_add_u32 v3, v4, 4, v3
    s_mov_b32 s36, s4
    s_mov_b32 s37, s5
    s_mov_b32 s38, 2621440
    s_mov_b32 s39, 0x00020000
    buffer_load_dwordx4 v[16:19], v3, s[36:39], 0 offen offset:0
    buffer_load_dwordx4 v[20:23], v3, s[36:39], 0 offen offset:256
    buffer_load_dwordx4 v[24:27], v3, s[36:39], 0 offen offset:512
    buffer_load_dwordx4 v[28:31], v3, s[36:39], 0 offen offset:768
    buffer_load_dwordx4 v[32:35], v3, s[36:39], 0 offen offset:1024
    s_mov_b32 s56, s20
    s_mov_b32 s57, s21
    s_mov_b32 s58, 256
    s_mov_b32 s59, 0x00020000
    s_add_u32 s3, s2, s25
    s_cmp_lg_u32 s3, 0
    s_cbranch_scc1 L_nonce1
    s_memrealtime s[60:61]
    s_waitcnt lgkmcnt(0)
    s_or_b32 s60, s60, 1
    s_or_b32 s61, s61, 0x9e370000
    v_mov_b32 v10, s60
    v_mov_b32 v11, s61
    v_mov_b32 v12, 0
    s_mov_b64 exec, 1
    buffer_store_dwordx2 v[10:11], v12, s[56:59], 0 offen sc1
    s_mov_b64 exec, -1
L_nonce1:
    v_and_b32 v4, 3, v2
    v_lshrrev_b32 v5, 2, v2
    v_lshl_add_u32 v6, v4, 4, v5
    v_lshlrev_b32 v6, 2, v6
    s_lshl_b32 s3, s2, 3
    s_lshl_b32 s26, s25, 2
    s_add_u32 s3, s3, s26
    s_lshr_b32 s26, s3, 5
    s_mul_i32 s26, s26, 40960
    s_and_b32 s3, s3, 31
    s_lshl_b32 s3, s3, 4
    s_add_u32 s26, s26, s3
    v_lshrrev_b32 v7, 1, v5
    v_lshlrev_b32 v7, 10, v7
    v_and_b32 v5, 1, v5
    v_lshl_add_u32 v7, v5, 9, v7
    v_lshl_add_u32 v7, v4, 4, v7
    v_add_u32 v7, s26, v7
    s_mov_b32 s40, 0
    s_mov_b32 s41, 8192
    s_mov_b32 s42, 16384
    s_mov_b32 s43, 24576
    s_mov_b32 s44, 32768
    s_waitcnt vmcnt(0)
    v_mov_b32 v12, 0
    buffer_load_dwordx2 v[10:11], v12, s[56:59], 0 offen sc1
L_a_lnbody:
    v_lshlrev_b32 v40, 16, v16
    v_and_b32 v41, 0xffff0000, v16
    v_lshlrev_b32 v42, 16, v17
    v_and_b32 v43, 0xffff0000, v17
    v_lshlrev_b32 v44, 16, v18
    v_and_b32 v45, 0xffff0000, v18
    v_lshlrev_b32 v46, 16, v19
    v_and_b32 v47, 0xffff0000, v19
    v_lshlrev_b32 v48, 16, v20
    v_and_b32 v49, 0xffff0000, v20
    v_lshlrev_b32 v50, 16, v21
    v_and_b32 v51, 0xffff0000, v21
    v_lshlrev_b32 v52, 16, v22
    v_and_b32 v53, 0xffff0000, v22
    v_lshlrev_b32 v54, 16, v23
    v_and_b32 v55, 0xffff0000, v23
    v_lshlrev_b32 v56, 16, v24
    v_and_b32 v57, 0xffff0000, v24
    v_lshlrev_b32 v58, 16, v25
    v_and_b32 v59, 0xffff0000, v25
    v_lshlrev_b32 v60, 16, v26
    v_and_b32 v61, 0xffff0000, v26
    v_lshlrev_b32 v62, 16, v27
    v_and_b32 v63, 0xffff0000, v27
    v_lshlrev_b32 v64, 16, v28
    v_and_b32 v65, 0xffff0000, v28
    v_lshlrev_b32 v66, 16, v29
    v_and_b32 v67, 0xffff0000, v29
    v_lshlrev_b32 v68, 16, v30
    v_and_b32 v69, 0xffff0000, v30
    v_lshlrev_b32 v70, 16, v31
    v_and_b32 v71, 0xffff0000, v31
    v_lshlrev_b32 v72, 16, v32
    v_and_b32 v73, 0xffff0000, v32
    v_lshlrev_b32 v74, 16, v33
    v_and_b32 v75, 0xffff0000, v33
    v_lshlrev_b32 v76, 16, v34
    v_and_b32 v77, 0xffff0000, v34
    v_lshlrev_b32 v78, 16, v35
    v_and_b32 v79, 0xffff0000, v35
    v_pk_add_f32 v[80:81], v[40:41], v[42:43]
    v_pk_mul_f32 v[82:83], v[40:41], v[40:41]
    v_pk_add_f32 v[86:87], v[44:45], v[46:47]
    v_pk_mul_f32 v[84:85], v[42:43], v[42:43]
    v_pk_fma_f32 v[82:83], v[44:45], v[44:45], v[82:83]
    v_pk_fma_f32 v[84:85], v[46:47], v[46:47], v[84:85]
    v_pk_fma_f32 v[82:83], v[48:49], v[48:49], v[82:83]
    v_pk_add_f32 v[80:81], v[80:81], v[48:49]
    v_pk_fma_f32 v[84:85], v[50:51], v[50:51], v[84:85]
    v_pk_add_f32 v[86:87], v[86:87], v[50:51]
    v_pk_fma_f32 v[82:83], v[52:53], v[52:53], v[82:83]
    v_pk_add_f32 v[80:81], v[80:81], v[52:53]
    v_pk_fma_f32 v[84:85], v[54:55], v[54:55], v[84:85]
    v_pk_add_f32 v[86:87], v[86:87], v[54:55]
    v_pk_fma_f32 v[82:83], v[56:57], v[56:57], v[82:83]
    v_pk_add_f32 v[80:81], v[80:81], v[56:57]
    v_pk_fma_f32 v[84:85], v[58:59], v[58:59], v[84:85]
    v_pk_add_f32 v[86:87], v[86:87], v[58:59]
    v_pk_fma_f32 v[82:83], v[60:61], v[60:61], v[82:83]
    v_pk_add_f32 v[80:81], v[80:81], v[60:61]
    v_pk_fma_f32 v[84:85], v[62:63], v[62:63], v[84:85]
    v_pk_add_f32 v[86:87], v[86:87], v[62:63]
    v_pk_fma_f32 v[82:83], v[64:65], v[64:65], v[82:83]
    v_pk_add_f32 v[80:81], v[80:81], v[64:65]
    v_pk_fma_f32 v[84:85], v[66:67], v[66:67], v[84:85]
    v_pk_add_f32 v[86:87], v[86:87], v[66:67]
    v_pk_fma_f32 v[82:83], v[68:69], v[68:69], v[82:83]
    v_pk_add_f32 v[80:81], v[80:81], v[68:69]
    v_pk_fma_f32 v[84:85], v[70:71], v[70:71], v[84:85]
    v_pk_add_f32 v[86:87], v[86:87], v[70:71]
    v_pk_fma_f32 v[82:83], v[72:73], v[72:73], v[82:83]
    v_pk_add_f32 v[80:81], v[80:81], v[72:73]
    v_pk_fma_f32 v[84:85], v[74:75], v[74:75], v[84:85]
    v_pk_add_f32 v[86:87], v[86:87], v[74:75]
    v_pk_fma_f32 v[82:83], v[76:77], v[76:77], v[82:83]
    v_pk_add_f32 v[80:81], v[80:81], v[76:77]
    v_pk_fma_f32 v[84:85], v[78:79], v[78:79], v[84:85]
    v_pk_add_f32 v[86:87], v[86:87], v[78:79]
    v_pk_add_f32 v[80:81], v[80:81], v[86:87]
    v_pk_add_f32 v[82:83], v[82:83], v[84:85]
    v_add_f32 v80, v80, v81
    v_add_f32 v82, v82, v83
    s_nop 0
    v_add_f32_dpp v80, v80, v80 row_ror:8 row_mask:0xf bank_mask:0xf
    v_add_f32_dpp v82, v82, v82 row_ror:8 row_mask:0xf bank_mask:0xf
    s_nop 0
    v_add_f32_dpp v80, v80, v80 row_ror:4 row_mask:0xf bank_mask:0xf
    v_add_f32_dpp v82, v82, v82 row_ror:4 row_mask:0xf bank_mask:0xf
    s_nop 0
    v_add_f32_dpp v80, v80, v80 row_ror:2 row_mask:0xf bank_mask:0xf
    v_add_f32_dpp v82, v82, v82 row_ror:2 row_mask:0xf bank_mask:0xf
    s_nop 0
    v_add_f32_dpp v80, v80, v80 row_ror:1 row_mask:0xf bank_mask:0xf
    v_add_f32_dpp v82, v82, v82 row_ror:1 row_mask:0xf bank_mask:0xf
    v_mul_f32 v84, 0xbacccccd, v80
    v_mul_f32 v80, 0x3acccccd, v82
    v_fma_f32 v80, -v84, v84, v80
    v_max_f32 v80, 0, v80
    v_cvt_pk_bf16_f32 v82, v84, v80
    v_lshlrev_b32 v84, 16, v82
    v_lshlrev_b32 v85, 16, v82
    v_and_b32 v80, 0xffff0000, v82
    v_add_f32 v80, 0x3727c5ac, v80
    v_cvt_pk_bf16_f32 v80, v80, v80
    v_and_b32 v80, 0xffff0000, v80
    v_sqrt_f32 v80, v80
    s_nop 0
    v_cvt_pk_bf16_f32 v80, v80, v80
    v_and_b32 v80, 0xffff0000, v80
    v_rcp_f32 v80, v80
    s_nop 0
    v_mov_b32 v81, v80
    v_pk_mul_f32 v[82:83], v[84:85], v[80:81]
    v_pk_fma_f32 v[40:41], v[40:41], v[80:81], v[82:83]
    v_cvt_pk_bf16_f32 v16, v40, v41
    v_pk_fma_f32 v[42:43], v[42:43], v[80:81], v[82:83]
    v_cvt_pk_bf16_f32 v17, v42, v43
    v_pk_fma_f32 v[44:45], v[44:45], v[80:81], v[82:83]
    v_cvt_pk_bf16_f32 v18, v44, v45
    v_pk_fma_f32 v[46:47], v[46:47], v[80:81], v[82:83]
    v_cvt_pk_bf16_f32 v19, v46, v47
    ds_bpermute_b32 v92, v6, v16
    ds_bpermute_b32 v93, v6, v17
    ds_bpermute_b32 v94, v6, v18
    ds_bpermute_b32 v95, v6, v19
    v_pk_fma_f32 v[48:49], v[48:49], v[80:81], v[82:83]
    v_cvt_pk_bf16_f32 v20, v48, v49
    v_pk_fma_f32 v[50:51], v[50:51], v[80:81], v[82:83]
    v_cvt_pk_bf16_f32 v21, v50, v51
    v_pk_fma_f32 v[52:53], v[52:53], v[80:81], v[82:83]
    v_cvt_pk_bf16_f32 v22, v52, v53
    v_pk_fma_f32 v[54:55], v[54:55], v[80:81], v[82:83]
    v_cvt_pk_bf16_f32 v23, v54, v55
    ds_bpermute_b32 v96, v6, v20
    ds_bpermute_b32 v97, v6, v21
    ds_bpermute_b32 v98, v6, v22
    ds_bpermute_b32 v99, v6, v23
    v_pk_fma_f32 v[56:57], v[56:57], v[80:81], v[82:83]
    v_cvt_pk_bf16_f32 v24, v56, v57
    v_pk_fma_f32 v[58:59], v[58:59], v[80:81], v[82:83]
    v_cvt_pk_bf16_f32 v25, v58, v59
    v_pk_fma_f32 v[60:61], v[60:61], v[80:81], v[82:83]
    v_cvt_pk_bf16_f32 v26, v60, v61
    v_pk_fma_f32 v[62:63], v[62:63], v[80:81], v[82:83]
    v_cvt_pk_bf16_f32 v27, v62, v63
    ds_bpermute_b32 v100, v6, v24
    ds_bpermute_b32 v101, v6, v25
    ds_bpermute_b32 v102, v6, v26
    ds_bpermute_b32 v103, v6, v27
    v_pk_fma_f32 v[64:65], v[64:65], v[80:81], v[82:83]
    v_cvt_pk_bf16_f32 v28, v64, v65
    v_pk_fma_f32 v[66:67], v[66:67], v[80:81], v[82:83]
    v_cvt_pk_bf16_f32 v29, v66, v67
    v_pk_fma_f32 v[68:69], v[68:69], v[80:81], v[82:83]
    v_cvt_pk_bf16_f32 v30, v68, v69
    v_pk_fma_f32 v[70:71], v[70:71], v[80:81], v[82:83]
    v_cvt_pk_bf16_f32 v31, v70, v71
    ds_bpermute_b32 v104, v6, v28
    ds_bpermute_b32 v105, v6, v29
    ds_bpermute_b32 v106, v6, v30
    ds_bpermute_b32 v107, v6, v31
    v_pk_fma_f32 v[72:73], v[72:73], v[80:81], v[82:83]
    v_cvt_pk_bf16_f32 v32, v72, v73
    v_pk_fma_f32 v[74:75], v[74:75], v[80:81], v[82:83]
    v_cvt_pk_bf16_f32 v33, v74, v75
    v_pk_fma_f32 v[76:77], v[76:77], v[80:81], v[82:83]
    v_cvt_pk_bf16_f32 v34, v76, v77
    v_pk_fma_f32 v[78:79], v[78:79], v[80:81], v[82:83]
    v_cvt_pk_bf16_f32 v35, v78, v79
    ds_bpermute_b32 v108, v6, v32
    ds_bpermute_b32 v109, v6, v33
    ds_bpermute_b32 v110, v6, v34
    ds_bpermute_b32 v111, v6, v35
    s_waitcnt lgkmcnt(15)
    buffer_store_dwordx4 v[92:95], v7, s[32:35], s40 offen sc1
    s_waitcnt lgkmcnt(12)
    buffer_store_dwordx4 v[96:99], v7, s[32:35], s41 offen sc1
    s_waitcnt lgkmcnt(8)
    buffer_store_dwordx4 v[100:103], v7, s[32:35], s42 offen sc1
    s_waitcnt lgkmcnt(4)
    buffer_store_dwordx4 v[104:107], v7, s[32:35], s43 offen sc1
    s_waitcnt lgkmcnt(0)
    buffer_store_dwordx4 v[108:111], v7, s[32:35], s44 offen sc1
    s_barrier
    s_mov_b32 s83, 0x40000
    s_branch L_wn2_chk
L_wn2:
    buffer_load_dwordx2 v[10:11], v12, s[56:59], 0 offen sc1
L_wn2_chk:
    s_waitcnt vmcnt(0)
    v_readfirstlane_b32 s60, v10
    v_readfirstlane_b32 s61, v11
    s_min_u32 s62, s60, s61
    s_cmp_lg_u32 s62, 0
    s_cbranch_scc1 L_wn2_ok
    s_sleep 1
    s_sub_u32 s83, s83, 1
    s_cbranch_scc0 L_wn2
L_wn2_ok:
    s_lshl_b32 s63, s2, 1
    s_add_u32 s63, s63, s25
    s_lshl_b32 s62, s63, 7
    s_add_u32 s62, s62, 20971520
    v_mov_b32 v0, 0
    v_mov_b32 v10, s60
    v_mov_b32 v11, s61
    s_mov_b64 exec, 1
    buffer_store_dwordx2 v[10:11], v0, s[32:35], s62 offen sc1
    s_mov_b64 exec, -1
    s_branch L_a_ln_done
L_a_noln:
    s_cmp_lg_u32 s25, 7
    s_cbranch_scc1 L_a_non2
    s_mov_b32 s56, s20
    s_mov_b32 s57, s21
    s_mov_b32 s58, 256
    s_mov_b32 s59, 0x00020000
    s_mov_b32 s83, 0x40000
    v_mov_b32 v12, 0
L_wn3:
    buffer_load_dwordx2 v[10:11], v12, s[56:59], 0 offen sc1
L_wn3_chk:
    s_waitcnt vmcnt(0)
    v_readfirstlane_b32 s60, v10
    v_readfirstlane_b32 s61, v11
    s_min_u32 s62, s60, s61
    s_cmp_lg_u32 s62, 0
    s_cbranch_scc1 L_wn3_ok
    s_sleep 6
    s_sub_u32 s83, s83, 1
    s_cbranch_scc0 L_wn3
L_wn3_ok:
L_a_non2:
    s_barrier
L_a_ln_done:
    s_cmp_ge_u32 s2, 240
    s_cbranch_scc1 L_a_spare
    s_and_b32 s24, s2, 7
    s_lshr_b32 s26, s2, 3
    s_lshr_b32 s27, s24, 2
    s_lshl_b32 s27, s27, 2
    s_and_b32 s24, s24, 3
    s_mul_i32 s24, s24, 30
    s_add_u32 s24, s24, s26
    s_and_b32 s3, s24, 3
    s_add_u32 s27, s27, s3
    s_lshr_b32 s47, s24, 2
    s_lshl_b32 s46, s47, 3
    s_add_u32 s46, s46, s27
    s_lshl_b32 s26, s27, 3
    s_add_u32 s26, s26, s25
    s_cmp_ge_u32 s47, 10
    s_cselect_b32 s24, 1, 0
    s_cmp_ge_u32 s47, 20
    s_cselect_b32 s24, 2, s24
    s_mul_i32 s3, s24, 10
    s_sub_u32 s27, s47, s3
    s_cmp_lt_u32 s25, 4
    s_cbranch_scc1 L_a_nodma
    s_mov_b32 s28, s6
    s_mov_b32 s29, s7
    s_mov_b32 s30, 2457600
    s_mov_b32 s31, 0x00020000
    v_lshrrev_b32 v4, 3, v2
    v_bfe_u32 v5, v2, 2, 1
    v_bfe_u32 v6, v2, 4, 1
    v_xor_b32 v5, v5, v6
    v_lshlrev_b32 v5, 6, v5
    v_and_b32 v6, 3, v2
    v_lshl_add_u32 v5, v6, 4, v5
    s_movk_i32 s3, 3840
    v_mad_u32_u24 v4, v4, s3, v5
    s_sub_u32 s3, s25, 4
    s_lshl_b32 s41, s47, 7
    s_mul_i32 s42, s3, 30720
    s_add_u32 s41, s41, s42
    s_lshl_b32 s42, s3, 10
    s_add_u32 m0, s42, 0
    s_add_u32 s3, s41, 0
    buffer_load_dwordx4 v4, s[28:31], s3 offen lds
    s_add_u32 m0, s42, 4096
    s_add_u32 s3, s41, 122880
    buffer_load_dwordx4 v4, s[28:31], s3 offen lds
    s_add_u32 m0, s42, 8192
    s_add_u32 s3, s41, 245760
    buffer_load_dwordx4 v4, s[28:31], s3 offen lds
    s_add_u32 m0, s42, 12288
    s_add_u32 s3, s41, 368640
    buffer_load_dwordx4 v4, s[28:31], s3 offen lds
    s_add_u32 m0, s42, 16384
    s_add_u32 s3, s41, 491520
    buffer_load_dwordx4 v4, s[28:31], s3 offen lds
    s_add_u32 m0, s42, 20480
    s_add_u32 s3, s41, 614400
    buffer_load_dwordx4 v4, s[28:31], s3 offen lds
    s_add_u32 m0, s42, 24576
    s_add_u32 s3, s41, 737280
    buffer_load_dwordx4 v4, s[28:31], s3 offen lds
    s_add_u32 m0, s42, 28672
    s_add_u32 s3, s41, 860160
    buffer_load_dwordx4 v4, s[28:31], s3 offen lds
    s_add_u32 m0, s42, 32768
    s_add_u32 s3, s41, 983040
    buffer_load_dwordx4 v4, s[28:31], s3 offen lds
    s_add_u32 m0, s42, 36864
    s_add_u32 s3, s41, 1105920
    buffer_load_dwordx4 v4, s[28:31], s3 offen lds
    s_add_u32 m0, s42, 40960
    s_add_u32 s3, s41, 1228800
    buffer_load_dwordx4 v4, s[28:31], s3 offen lds
    s_add_u32 m0, s42, 45056
    s_add_u32 s3, s41, 1351680
    buffer_load_dwordx4 v4, s[28:31], s3 offen lds
    s_add_u32 m0, s42, 49152
    s_add_u32 s3, s41, 1474560
    buffer_load_dwordx4 v4, s[28:31], s3 offen lds
    s_add_u32 m0, s42, 53248
    s_add_u32 s3, s41, 1597440
    buffer_load_dwordx4 v4, s[28:31], s3 offen lds
    s_add_u32 m0, s42, 57344
    s_add_u32 s3, s41, 1720320
    buffer_load_dwordx4 v4, s[28:31], s3 offen lds
    s_add_u32 m0, s42, 61440
    s_add_u32 s3, s41, 1843200
    buffer_load_dwordx4 v4, s[28:31], s3 offen lds
    s_add_u32 m0, s42, 65536
    s_add_u32 s3, s41, 1966080
    buffer_load_dwordx4 v4, s[28:31], s3 offen lds
    s_add_u32 m0, s42, 69632
    s_add_u32 s3, s41, 2088960
    buffer_load_dwordx4 v4, s[28:31], s3 offen lds
    s_add_u32 m0, s42, 73728
    s_add_u32 s3, s41, 2211840
    buffer_load_dwordx4 v4, s[28:31], s3 offen lds
    s_add_u32 m0, s42, 77824
    s_add_u32 s3, s41, 2334720
    buffer_load_dwordx4 v4, s[28:31], s3 offen lds
    s_cmp_lg_u32 s25, 7
    s_cbranch_scc1 L_a_nodma
    s_and_b32 s63, s46, 7
    s_lshl_b32 s63, s63, 6
    v_and_b32 v0, 63, v2
    v_add_u32 v0, s63, v0
    v_lshlrev_b32 v0, 7, v0
    v_add_u32 v0, 20971520, v0
    buffer_load_dwordx2 v[126:127], v0, s[32:35], 0 offen sc1
L_a_nodma:
    s_mul_i32 s40, s26, 40960
    s_add_u32 s40, s40, 0
    v_bfe_u32 v6, v2, 2, 2
    v_lshrrev_b32 v7, 5, v2
    v_lshl_add_u32 v8, v7, 3, v6
    v_lshlrev_b32 v8, 7, v8
    v_bfe_u32 v10, v2, 4, 1
    v_lshl_add_u32 v8, v10, 5, v8
    v_lshrrev_b32 v6, 1, v6
    v_lshl_add_u32 v8, v6, 6, v8
    v_and_b32 v10, 31, v2
    v_mov_b32 v16, 0
    v_mov_b32 v17, 0
    v_mov_b32 v18, 0
    v_mov_b32 v19, 0
    v_mov_b32 v20, 0
    v_mov_b32 v21, 0
    v_mov_b32 v22, 0
    v_mov_b32 v23, 0
    v_mov_b32 v24, 0
    v_mov_b32 v25, 0
    v_mov_b32 v26, 0
    v_mov_b32 v27, 0
    v_mov_b32 v28, 0
    v_mov_b32 v29, 0
    v_mov_b32 v30, 0
    v_mov_b32 v31, 0
    v_mov_b32 v32, 0
    v_mov_b32 v33, 0
    v_mov_b32 v34, 0
    v_mov_b32 v35, 0
    v_mov_b32 v36, 0
    v_mov_b32 v37, 0
    v_mov_b32 v38, 0
    v_mov_b32 v39, 0
    v_mov_b32 v40, 0
    v_mov_b32 v41, 0
    v_mov_b32 v42, 0
    v_mov_b32 v43, 0
    v_mov_b32 v44, 0
    v_mov_b32 v45, 0
    v_mov_b32 v46, 0
    v_mov_b32 v47, 0
    s_cmp_eq_u32 s24, 2
    s_cbranch_scc1 L_qkv_V
    v_and_b32 v11, 1, v2
    v_lshlrev_b32 v11, 4, v11
    v_bfe_u32 v12, v2, 1, 1
    v_lshl_add_u32 v11, v12, 3, v11
    v_add_u32 v4, v8, v11
    v_xor_b32 v5, 64, v4
    v_xor_b32 v124, 512, v4
    v_xor_b32 v125, 512, v5
    s_lshl_b32 s45, s26, 10
    s_add_u32 s45, s45, 2621440
    s_lshl_b32 s43, s26, 8
    s_add_u32 s43, s43, 4718592
    s_mov_b32 s44, 65536
    s_mov_b32 s42, 16384
    s_mov_b32 s48, 0x3ea52b5c
    s_cmp_eq_u32 s24, 0
    s_cbranch_scc1 L_qkv_isq
    s_mul_i32 s45, s26, 2560
    s_add_u32 s45, s45, 5242880
    s_add_u32 s43, s45, 1024
    s_mov_b32 s44, 163840
    s_mov_b32 s42, 163840
    s_mov_b32 s48, 1.0
L_qkv_isq:
    s_mov_b32 s49, s48
    s_lshl_b32 s3, s27, 3
    v_add_u32 v11, s3, v7
    v_lshl_add_u32 v12, v10, 4, s45
    v_lshl_add_u32 v13, v10, 3, s43
    s_mov_b32 s50, 2147483632
    s_mov_b32 s51, 0
    s_mov_b32 s80, 0x55555555
    s_mov_b32 s81, 0x55555555
    v_add_u32 v14, 0, v11
    v_mul_u32_u24 v15, 205, v14
    v_lshrrev_b32 v15, 10, v15
    v_mul_u32_u24 v3, 5, v15
    v_sub_u32 v14, v14, v3
    v_lshlrev_b32 v15, 1, v15
    v_mul_lo_u32 v3, v15, s42
    v_add_u32 v113, v3, v13
    v_add_u32 v114, s42, v113
    v_cmp_lt_u32 vcc, 2, v14
    v_subrev_u32 v3, 3, v14
    s_nop 0
    v_addc_co_u32 v15, s[52:53], 0, v15, vcc
    v_cndmask_b32 v3, v14, v3, vcc
    v_mul_lo_u32 v15, v15, s44
    v_lshl_add_u32 v3, v3, 9, v12
    v_add_u32 v3, v3, v15
    v_cmp_eq_u32 vcc, 2, v14
    v_mov_b32 v15, s50
    s_cmp_lg_u64 vcc, 0
    s_cselect_b32 s3, 1, 0
    s_or_b32 s51, s51, s3
    s_and_b64 s[64:65], vcc, s[80:81]
    s_andn2_b64 s[66:67], vcc, s[80:81]
    v_subrev_u32 v15, 8, v114
    v_cndmask_b32 v112, v3, v113, s[64:65]
    v_cndmask_b32 v112, v112, v15, s[66:67]
    v_add_u32 v14, 2, v11
    v_mul_u32_u24 v15, 205, v14
    v_lshrrev_b32 v15, 10, v15
    v_mul_u32_u24 v3, 5, v15
    v_sub_u32 v14, v14, v3
    v_lshlrev_b32 v15, 1, v15
    v_mul_lo_u32 v3, v15, s42
    v_add_u32 v116, v3, v13
    v_add_u32 v117, s42, v116
    v_cmp_lt_u32 vcc, 2, v14
    v_subrev_u32 v3, 3, v14
    s_nop 0
    v_addc_co_u32 v15, s[52:53], 0, v15, vcc
    v_cndmask_b32 v3, v14, v3, vcc
    v_mul_lo_u32 v15, v15, s44
    v_lshl_add_u32 v3, v3, 9, v12
    v_add_u32 v3, v3, v15
    v_cmp_eq_u32 vcc, 2, v14
    v_mov_b32 v15, s50
    s_cmp_lg_u64 vcc, 0
    s_cselect_b32 s3, 2, 0
    s_or_b32 s51, s51, s3
    s_and_b64 s[68:69], vcc, s[80:81]
    s_andn2_b64 s[70:71], vcc, s[80:81]
    v_subrev_u32 v15, 8, v117
    v_cndmask_b32 v115, v3, v116, s[68:69]
    v_cndmask_b32 v115, v115, v15, s[70:71]
    v_add_u32 v14, 4, v11
    v_mul_u32_u24 v15, 205, v14
    v_lshrrev_b32 v15, 10, v15
    v_mul_u32_u24 v3, 5, v15
    v_sub_u32 v14, v14, v3
    v_lshlrev_b32 v15, 1, v15
    v_mul_lo_u32 v3, v15, s42
    v_add_u32 v119, v3, v13
    v_add_u32 v120, s42, v119
    v_cmp_lt_u32 vcc, 2, v14
    v_subrev_u32 v3, 3, v14
    s_nop 0
    v_addc_co_u32 v15, s[52:53], 0, v15, vcc
    v_cndmask_b32 v3, v14, v3, vcc
    v_mul_lo_u32 v15, v15, s44
    v_lshl_add_u32 v3, v3, 9, v12
    v_add_u32 v3, v3, v15
    v_cmp_eq_u32 vcc, 2, v14
    v_mov_b32 v15, s50
    s_cmp_lg_u64 vcc, 0
    s_cselect_b32 s3, 4, 0
    s_or_b32 s51, s51, s3
    s_and_b64 s[72:73], vcc, s[80:81]
    s_andn2_b64 s[74:75], vcc, s[80:81]
    v_subrev_u32 v15, 8, v120
    v_cndmask_b32 v118, v3, v119, s[72:73]
    v_cndmask_b32 v118, v118, v15, s[74:75]
    v_add_u32 v14, 6, v11
    v_mul_u32_u24 v15, 205, v14
    v_lshrrev_b32 v15, 10, v15
    v_mul_u32_u24 v3, 5, v15
    v_sub_u32 v14, v14, v3
    v_lshlrev_b32 v15, 1, v15
    v_mul_lo_u32 v3, v15, s42
    v_add_u32 v122, v3, v13
    v_add_u32 v123, s42, v122
    v_cmp_lt_u32 vcc, 2, v14
    v_subrev_u32 v3, 3, v14
    s_nop 0
    v_addc_co_u32 v15, s[52:53], 0, v15, vcc
    v_cndmask_b32 v3, v14, v3, vcc
    v_mul_lo_u32 v15, v15, s44
    v_lshl_add_u32 v3, v3, 9, v12
    v_add_u32 v3, v3, v15
    v_cmp_eq_u32 vcc, 2, v14
    v_mov_b32 v15, s50
    s_cmp_lg_u64 vcc, 0
    s_cselect_b32 s3, 8, 0
    s_or_b32 s51, s51, s3
    s_and_b64 s[76:77], vcc, s[80:81]
    s_andn2_b64 s[78:79], vcc, s[80:81]
    v_subrev_u32 v15, 8, v123
    v_cndmask_b32 v121, v3, v122, s[76:77]
    v_cndmask_b32 v121, v121, v15, s[78:79]
    s_cmp_lg_u32 s25, 7
    s_cbranch_scc1 L_w24
    s_waitcnt vmcnt(0)
    v_cmp_ne_u64 vcc, s[60:61], v[126:127]
    s_cbranch_vccz L_w24
    s_mov_b64 exec, vcc
    s_mov_b32 s83, 0x40000
L_poll5_2:
    buffer_load_dwordx2 v[126:127], v0, s[32:35], 0 offen sc1
    s_waitcnt vmcnt(0)
    v_cmp_ne_u64 vcc, s[60:61], v[126:127]
    s_cbranch_vccz L_poll5_ok
    s_mov_b64 exec, vcc
    s_sleep 1
    s_sub_u32 s83, s83, 1
    s_cbranch_scc0 L_poll5_2
L_poll5_ok:
    s_mov_b64 exec, -1
L_w24:
    s_cmp_lt_u32 s25, 4
    s_cbranch_scc1 L_w24_a
    s_waitcnt vmcnt(0)
L_w24_a:
    s_barrier
    buffer_load_dwordx4 v[48:51], v9, s[32:35], s40 offen offset:0 sc1
    buffer_load_dwordx4 v[52:55], v9, s[32:35], s40 offen offset:1024 sc1
    buffer_load_dwordx4 v[56:59], v9, s[32:35], s40 offen offset:2048 sc1
    buffer_load_dwordx4 v[60:63], v9, s[32:35], s40 offen offset:3072 sc1
    s_add_u32 s40, s40, 4096
    ds_read_b64_tr_b16 v[96:97], v4 offset:0
    ds_read_b64_tr_b16 v[98:99], v124 offset:0
    ds_read_b64_tr_b16 v[100:101], v5 offset:0
    ds_read_b64_tr_b16 v[102:103], v125 offset:0
    ds_read_b64_tr_b16 v[104:105], v4 offset:2048
    ds_read_b64_tr_b16 v[106:107], v124 offset:2048
    ds_read_b64_tr_b16 v[108:109], v5 offset:2048
    ds_read_b64_tr_b16 v[110:111], v125 offset:2048
    s_waitcnt vmcnt(3) lgkmcnt(4)
    v_mfma_f32_32x32x16_bf16 v[16:31], v[96:99], v[48:51], v[16:31]
    v_mfma_f32_32x32x16_bf16 v[32:47], v[100:103], v[48:51], v[32:47]
    buffer_load_dwordx4 v[64:67], v9, s[32:35], s40 offen offset:0 sc1
    buffer_load_dwordx4 v[68:71], v9, s[32:35], s40 offen offset:1024 sc1
    ds_read_b64_tr_b16 v[96:97], v4 offset:4096
    ds_read_b64_tr_b16 v[98:99], v124 offset:4096
    ds_read_b64_tr_b16 v[100:101], v5 offset:4096
    ds_read_b64_tr_b16 v[102:103], v125 offset:4096
    s_waitcnt vmcnt(4) lgkmcnt(4)
    v_mfma_f32_32x32x16_bf16 v[16:31], v[104:107], v[52:55], v[16:31]
    v_mfma_f32_32x32x16_bf16 v[32:47], v[108:111], v[52:55], v[32:47]
    buffer_load_dwordx4 v[72:75], v9, s[32:35], s40 offen offset:2048 sc1
    buffer_load_dwordx4 v[76:79], v9, s[32:35], s40 offen offset:3072 sc1
    s_add_u32 s40, s40, 4096
    ds_read_b64_tr_b16 v[104:105], v4 offset:6144
    ds_read_b64_tr_b16 v[106:107], v124 offset:6144
    ds_read_b64_tr_b16 v[108:109], v5 offset:6144
    ds_read_b64_tr_b16 v[110:111], v125 offset:6144
    s_waitcnt vmcnt(5) lgkmcnt(4)
    v_mfma_f32_32x32x16_bf16 v[16:31], v[96:99], v[56:59], v[16:31]
    v_mfma_f32_32x32x16_bf16 v[32:47], v[100:103], v[56:59], v[32:47]
    buffer_load_dwordx4 v[80:83], v9, s[32:35], s40 offen offset:0 sc1
    buffer_load_dwordx4 v[84:87], v9, s[32:35], s40 offen offset:1024 sc1
    ds_read_b64_tr_b16 v[96:97], v4 offset:8192
    ds_read_b64_tr_b16 v[98:99], v124 offset:8192
    ds_read_b64_tr_b16 v[100:101], v5 offset:8192
    ds_read_b64_tr_b16 v[102:103], v125 offset:8192
    s_waitcnt vmcnt(6) lgkmcnt(4)
    v_mfma_f32_32x32x16_bf16 v[16:31], v[104:107], v[60:63], v[16:31]
    v_mfma_f32_32x32x16_bf16 v[32:47], v[108:111], v[60:63], v[32:47]
    buffer_load_dwordx4 v[88:91], v9, s[32:35], s40 offen offset:2048 sc1
    buffer_load_dwordx4 v[92:95], v9, s[32:35], s40 offen offset:3072 sc1
    s_add_u32 s40, s40, 4096
    ds_read_b64_tr_b16 v[104:105], v4 offset:10240
    ds_read_b64_tr_b16 v[106:107], v124 offset:10240
    ds_read_b64_tr_b16 v[108:109], v5 offset:10240
    ds_read_b64_tr_b16 v[110:111], v125 offset:10240
    s_waitcnt vmcnt(7) lgkmcnt(4)
    v_mfma_f32_32x32x16_bf16 v[16:31], v[96:99], v[64:67], v[16:31]
    v_mfma_f32_32x32x16_bf16 v[32:47], v[100:103], v[64:67], v[32:47]
    buffer_load_dwordx4 v[48:51], v9, s[32:35], s40 offen offset:0 sc1
    buffer_load_dwordx4 v[52:55], v9, s[32:35], s40 offen offset:1024 sc1
    ds_read_b64_tr_b16 v[96:97], v4 offset:12288
    ds_read_b64_tr_b16 v[98:99], v124 offset:12288
    ds_read_b64_tr_b16 v[100:101], v5 offset:12288
    ds_read_b64_tr_b16 v[102:103], v125 offset:12288
    s_waitcnt vmcnt(8) lgkmcnt(4)
    v_mfma_f32_32x32x16_bf16 v[16:31], v[104:107], v[68:71], v[16:31]
    v_mfma_f32_32x32x16_bf16 v[32:47], v[108:111], v[68:71], v[32:47]
    buffer_load_dwordx4 v[56:59], v9, s[32:35], s40 offen offset:2048 sc1
    buffer_load_dwordx4 v[60:63], v9, s[32:35], s40 offen offset:3072 sc1
    s_add_u32 s40, s40, 4096
    ds_read_b64_tr_b16 v[104:105], v4 offset:14336
    ds_read_b64_tr_b16 v[106:107], v124 offset:14336
    ds_read_b64_tr_b16 v[108:109], v5 offset:14336
    ds_read_b64_tr_b16 v[110:111], v125 offset:14336
    s_waitcnt vmcnt(9) lgkmcnt(4)
    v_mfma_f32_32x32x16_bf16 v[16:31], v[96:99], v[72:75], v[16:31]
    v_mfma_f32_32x32x16_bf16 v[32:47], v[100:103], v[72:75], v[32:47]
    buffer_load_dwordx4 v[64:67], v9, s[32:35], s40 offen offset:0 sc1
    buffer_load_dwordx4 v[68:71], v9, s[32:35], s40 offen offset:1024 sc1
    ds_read_b64_tr_b16 v[96:97], v4 offset:16384
    ds_read_b64_tr_b16 v[98:99], v124 offset:16384
    ds_read_b64_tr_b16 v[100:101], v5 offset:16384
    ds_read_b64_tr_b16 v[102:103], v125 offset:16384
    s_waitcnt vmcnt(10) lgkmcnt(4)
    v_mfma_f32_32x32x16_bf16 v[16:31], v[104:107], v[76:79], v[16:31]
    v_mfma_f32_32x32x16_bf16 v[32:47], v[108:111], v[76:79], v[32:47]
    buffer_load_dwordx4 v[72:75], v9, s[32:35], s40 offen offset:2048 sc1
    buffer_load_dwordx4 v[76:79], v9, s[32:35], s40 offen offset:3072 sc1
    s_add_u32 s40, s40, 4096
    ds_read_b64_tr_b16 v[104:105], v4 offset:18432
    ds_read_b64_tr_b16 v[106:107], v124 offset:18432
    ds_read_b64_tr_b16 v[108:109], v5 offset:18432
    ds_read_b64_tr_b16 v[110:111], v125 offset:18432
    s_waitcnt vmcnt(11) lgkmcnt(4)
    v_mfma_f32_32x32x16_bf16 v[16:31], v[96:99], v[80:83], v[16:31]
    v_mfma_f32_32x32x16_bf16 v[32:47], v[100:103], v[80:83], v[32:47]
    buffer_load_dwordx4 v[80:83], v9, s[32:35], s40 offen offset:0 sc1
    ds_read_b64_tr_b16 v[96:97], v4 offset:20480
    ds_read_b64_tr_b16 v[98:99], v124 offset:20480
    ds_read_b64_tr_b16 v[100:101], v5 offset:20480
    ds_read_b64_tr_b16 v[102:103], v125 offset:20480
    s_waitcnt vmcnt(11) lgkmcnt(4)
    v_mfma_f32_32x32x16_bf16 v[16:31], v[104:107], v[84:87], v[16:31]
    v_mfma_f32_32x32x16_bf16 v[32:47], v[108:111], v[84:87], v[32:47]
    buffer_load_dwordx4 v[84:87], v9, s[32:35], s40 offen offset:1024 sc1
    ds_read_b64_tr_b16 v[104:105], v4 offset:22528
    ds_read_b64_tr_b16 v[106:107], v124 offset:22528
    ds_read_b64_tr_b16 v[108:109], v5 offset:22528
    ds_read_b64_tr_b16 v[110:111], v125 offset:22528
    s_waitcnt vmcnt(11) lgkmcnt(4)
    v_mfma_f32_32x32x16_bf16 v[16:31], v[96:99], v[88:91], v[16:31]
    v_mfma_f32_32x32x16_bf16 v[32:47], v[100:103], v[88:91], v[32:47]
    buffer_load_dwordx4 v[88:91], v9, s[32:35], s40 offen offset:2048 sc1
    ds_read_b64_tr_b16 v[96:97], v4 offset:24576
    ds_read_b64_tr_b16 v[98:99], v124 offset:24576
    ds_read_b64_tr_b16 v[100:101], v5 offset:24576
    ds_read_b64_tr_b16 v[102:103], v125 offset:24576
    s_waitcnt vmcnt(11) lgkmcnt(4)
    v_mfma_f32_32x32x16_bf16 v[16:31], v[104:107], v[92:95], v[16:31]
    v_mfma_f32_32x32x16_bf16 v[32:47], v[108:111], v[92:95], v[32:47]
    buffer_load_dwordx4 v[92:95], v9, s[32:35], s40 offen offset:3072 sc1
    s_add_u32 s40, s40, 4096
    ds_read_b64_tr_b16 v[104:105], v4 offset:26624
    ds_read_b64_tr_b16 v[106:107], v124 offset:26624
    ds_read_b64_tr_b16 v[108:109], v5 offset:26624
    ds_read_b64_tr_b16 v[110:111], v125 offset:26624
    s_waitcnt vmcnt(11) lgkmcnt(4)
    v_mfma_f32_32x32x16_bf16 v[16:31], v[96:99], v[48:51], v[16:31]
    v_mfma_f32_32x32x16_bf16 v[32:47], v[100:103], v[48:51], v[32:47]
    buffer_load_dwordx4 v[48:51], v9, s[32:35], s40 offen offset:0 sc1
    ds_read_b64_tr_b16 v[96:97], v4 offset:28672
    ds_read_b64_tr_b16 v[98:99], v124 offset:28672
    ds_read_b64_tr_b16 v[100:101], v5 offset:28672
    ds_read_b64_tr_b16 v[102:103], v125 offset:28672
    s_waitcnt vmcnt(11) lgkmcnt(4)
    v_mfma_f32_32x32x16_bf16 v[16:31], v[104:107], v[52:55], v[16:31]
    v_mfma_f32_32x32x16_bf16 v[32:47], v[108:111], v[52:55], v[32:47]
    buffer_load_dwordx4 v[52:55], v9, s[32:35], s40 offen offset:1024 sc1
    ds_read_b64_tr_b16 v[104:105], v4 offset:30720
    ds_read_b64_tr_b16 v[106:107], v124 offset:30720
    ds_read_b64_tr_b16 v[108:109], v5 offset:30720
    ds_read_b64_tr_b16 v[110:111], v125 offset:30720
    s_waitcnt vmcnt(11) lgkmcnt(4)
    v_mfma_f32_32x32x16_bf16 v[16:31], v[96:99], v[56:59], v[16:31]
    v_mfma_f32_32x32x16_bf16 v[32:47], v[100:103], v[56:59], v[32:47]
    buffer_load_dwordx4 v[56:59], v9, s[32:35], s40 offen offset:2048 sc1
    ds_read_b64_tr_b16 v[96:97], v4 offset:32768
    ds_read_b64_tr_b16 v[98:99], v124 offset:32768
    ds_read_b64_tr_b16 v[100:101], v5 offset:32768
    ds_read_b64_tr_b16 v[102:103], v125 offset:32768
    s_waitcnt vmcnt(11) lgkmcnt(4)
    v_mfma_f32_32x32x16_bf16 v[16:31], v[104:107], v[60:63], v[16:31]
    v_mfma_f32_32x32x16_bf16 v[32:47], v[108:111], v[60:63], v[32:47]
    buffer_load_dwordx4 v[60:63], v9, s[32:35], s40 offen offset:3072 sc1
    s_add_u32 s40, s40, 4096
    ds_read_b64_tr_b16 v[104:105], v4 offset:34816
    ds_read_b64_tr_b16 v[106:107], v124 offset:34816
    ds_read_b64_tr_b16 v[108:109], v5 offset:34816
    ds_read_b64_tr_b16 v[110:111], v125 offset:34816
    s_waitcnt vmcnt(11) lgkmcnt(4)
    v_mfma_f32_32x32x16_bf16 v[16:31], v[96:99], v[64:67], v[16:31]
    v_mfma_f32_32x32x16_bf16 v[32:47], v[100:103], v[64:67], v[32:47]
    buffer_load_dwordx4 v[64:67], v9, s[32:35], s40 offen offset:0 sc1
    ds_read_b64_tr_b16 v[96:97], v4 offset:36864
    ds_read_b64_tr_b16 v[98:99], v124 offset:36864
    ds_read_b64_tr_b16 v[100:101], v5 offset:36864
    ds_read_b64_tr_b16 v[102:103], v125 offset:36864
    s_waitcnt vmcnt(11) lgkmcnt(4)
    v_mfma_f32_32x32x16_bf16 v[16:31], v[104:107], v[68:71], v[16:31]
    v_mfma_f32_32x32x16_bf16 v[32:47], v[108:111], v[68:71], v[32:47]
    buffer_load_dwordx4 v[68:71], v9, s[32:35], s40 offen offset:1024 sc1
    ds_read_b64_tr_b16 v[104:105], v4 offset:38912
    ds_read_b64_tr_b16 v[106:107], v124 offset:38912
    ds_read_b64_tr_b16 v[108:109], v5 offset:38912
    ds_read_b64_tr_b16 v[110:111], v125 offset:38912
    s_waitcnt vmcnt(11) lgkmcnt(4)
    v_mfma_f32_32x32x16_bf16 v[16:31], v[96:99], v[72:75], v[16:31]
    v_mfma_f32_32x32x16_bf16 v[32:47], v[100:103], v[72:75], v[32:47]
    buffer_load_dwordx4 v[72:75], v9, s[32:35], s40 offen offset:2048 sc1
    ds_read_b64_tr_b16 v[96:97], v4 offset:40960
    ds_read_b64_tr_b16 v[98:99], v124 offset:40960
    ds_read_b64_tr_b16 v[100:101], v5 offset:40960
    ds_read_b64_tr_b16 v[102:103], v125 offset:40960
    s_waitcnt vmcnt(11) lgkmcnt(4)
    v_mfma_f32_32x32x16_bf16 v[16:31], v[104:107], v[76:79], v[16:31]
    v_mfma_f32_32x32x16_bf16 v[32:47], v[108:111], v[76:79], v[32:47]
    buffer_load_dwordx4 v[76:79], v9, s[32:35], s40 offen offset:3072 sc1
    s_add_u32 s40, s40, 4096
    ds_read_b64_tr_b16 v[104:105], v4 offset:43008
    ds_read_b64_tr_b16 v[106:107], v124 offset:43008
    ds_read_b64_tr_b16 v[108:109], v5 offset:43008
    ds_read_b64_tr_b16 v[110:111], v125 offset:43008
    s_waitcnt vmcnt(11) lgkmcnt(4)
    v_mfma_f32_32x32x16_bf16 v[16:31], v[96:99], v[80:83], v[16:31]
    v_mfma_f32_32x32x16_bf16 v[32:47], v[100:103], v[80:83], v[32:47]
    buffer_load_dwordx4 v[80:83], v9, s[32:35], s40 offen offset:0 sc1
    ds_read_b64_tr_b16 v[96:97], v4 offset:45056
    ds_read_b64_tr_b16 v[98:99], v124 offset:45056
    ds_read_b64_tr_b16 v[100:101], v5 offset:45056
    ds_read_b64_tr_b16 v[102:103], v125 offset:45056
    s_waitcnt vmcnt(11) lgkmcnt(4)
    v_mfma_f32_32x32x16_bf16 v[16:31], v[104:107], v[84:87], v[16:31]
    v_mfma_f32_32x32x16_bf16 v[32:47], v[108:111], v[84:87], v[32:47]
    buffer_load_dwordx4 v[84:87], v9, s[32:35], s40 offen offset:1024 sc1
    ds_read_b64_tr_b16 v[104:105], v4 offset:47104
    ds_read_b64_tr_b16 v[106:107], v124 offset:47104
    ds_read_b64_tr_b16 v[108:109], v5 offset:47104
    ds_read_b64_tr_b16 v[110:111], v125 offset:47104
    s_waitcnt vmcnt(11) lgkmcnt(4)
    v_mfma_f32_32x32x16_bf16 v[16:31], v[96:99], v[88:91], v[16:31]
    v_mfma_f32_32x32x16_bf16 v[32:47], v[100:103], v[88:91], v[32:47]
    buffer_load_dwordx4 v[88:91], v9, s[32:35], s40 offen offset:2048 sc1
    ds_read_b64_tr_b16 v[96:97], v4 offset:49152
    ds_read_b64_tr_b16 v[98:99], v124 offset:49152
    ds_read_b64_tr_b16 v[100:101], v5 offset:49152
    ds_read_b64_tr_b16 v[102:103], v125 offset:49152
    s_waitcnt vmcnt(11) lgkmcnt(4)
    v_mfma_f32_32x32x16_bf16 v[16:31], v[104:107], v[92:95], v[16:31]
    v_mfma_f32_32x32x16_bf16 v[32:47], v[108:111], v[92:95], v[32:47]
    buffer_load_dwordx4 v[92:95], v9, s[32:35], s40 offen offset:3072 sc1
    s_add_u32 s40, s40, 4096
    ds_read_b64_tr_b16 v[104:105], v4 offset:51200
    ds_read_b64_tr_b16 v[106:107], v124 offset:51200
    ds_read_b64_tr_b16 v[108:109], v5 offset:51200
    ds_read_b64_tr_b16 v[110:111], v125 offset:51200
    s_waitcnt vmcnt(11) lgkmcnt(4)
    v_mfma_f32_32x32x16_bf16 v[16:31], v[96:99], v[48:51], v[16:31]
    v_mfma_f32_32x32x16_bf16 v[32:47], v[100:103], v[48:51], v[32:47]
    buffer_load_dwordx4 v[48:51], v9, s[32:35], s40 offen offset:0 sc1
    ds_read_b64_tr_b16 v[96:97], v4 offset:53248
    ds_read_b64_tr_b16 v[98:99], v124 offset:53248
    ds_read_b64_tr_b16 v[100:101], v5 offset:53248
    ds_read_b64_tr_b16 v[102:103], v125 offset:53248
    s_waitcnt vmcnt(11) lgkmcnt(4)
    v_mfma_f32_32x32x16_bf16 v[16:31], v[104:107], v[52:55], v[16:31]
    v_mfma_f32_32x32x16_bf16 v[32:47], v[108:111], v[52:55], v[32:47]
    buffer_load_dwordx4 v[52:55], v9, s[32:35], s40 offen offset:1024 sc1
    ds_read_b64_tr_b16 v[104:105], v4 offset:55296
    ds_read_b64_tr_b16 v[106:107], v124 offset:55296
    ds_read_b64_tr_b16 v[108:109], v5 offset:55296
    ds_read_b64_tr_b16 v[110:111], v125 offset:55296
    s_waitcnt vmcnt(11) lgkmcnt(4)
    v_mfma_f32_32x32x16_bf16 v[16:31], v[96:99], v[56:59], v[16:31]
    v_mfma_f32_32x32x16_bf16 v[32:47], v[100:103], v[56:59], v[32:47]
    buffer_load_dwordx4 v[56:59], v9, s[32:35], s40 offen offset:2048 sc1
    ds_read_b64_tr_b16 v[96:97], v4 offset:57344
    ds_read_b64_tr_b16 v[98:99], v124 offset:57344
    ds_read_b64_tr_b16 v[100:101], v5 offset:57344
    ds_read_b64_tr_b16 v[102:103], v125 offset:57344
    s_waitcnt vmcnt(11) lgkmcnt(4)
    v_mfma_f32_32x32x16_bf16 v[16:31], v[104:107], v[60:63], v[16:31]
    v_mfma_f32_32x32x16_bf16 v[32:47], v[108:111], v[60:63], v[32:47]
    buffer_load_dwordx4 v[60:63], v9, s[32:35], s40 offen offset:3072 sc1
    s_add_u32 s40, s40, 4096
    ds_read_b64_tr_b16 v[104:105], v4 offset:59392
    ds_read_b64_tr_b16 v[106:107], v124 offset:59392
    ds_read_b64_tr_b16 v[108:109], v5 offset:59392
    ds_read_b64_tr_b16 v[110:111], v125 offset:59392
    s_waitcnt vmcnt(11) lgkmcnt(4)
    v_mfma_f32_32x32x16_bf16 v[16:31], v[96:99], v[64:67], v[16:31]
    v_mfma_f32_32x32x16_bf16 v[32:47], v[100:103], v[64:67], v[32:47]
    ds_read_b64_tr_b16 v[96:97], v4 offset:61440
    ds_read_b64_tr_b16 v[98:99], v124 offset:61440
    ds_read_b64_tr_b16 v[100:101], v5 offset:61440
    ds_read_b64_tr_b16 v[102:103], v125 offset:61440
    s_waitcnt vmcnt(10) lgkmcnt(4)
    v_mfma_f32_32x32x16_bf16 v[16:31], v[104:107], v[68:71], v[16:31]
    v_mfma_f32_32x32x16_bf16 v[32:47], v[108:111], v[68:71], v[32:47]
    ds_read_b64_tr_b16 v[104:105], v4 offset:63488
    ds_read_b64_tr_b16 v[106:107], v124 offset:63488
    ds_read_b64_tr_b16 v[108:109], v5 offset:63488
    ds_read_b64_tr_b16 v[110:111], v125 offset:63488
    s_waitcnt vmcnt(9) lgkmcnt(4)
    v_mfma_f32_32x32x16_bf16 v[16:31], v[96:99], v[72:75], v[16:31]
    v_mfma_f32_32x32x16_bf16 v[32:47], v[100:103], v[72:75], v[32:47]
    v_add_u32 v4, 0x10000, v4
    v_add_u32 v5, 0x10000, v5
    v_add_u32 v124, 0x10000, v124
    v_add_u32 v125, 0x10000, v125
    ds_read_b64_tr_b16 v[96:97], v4 offset:0
    ds_read_b64_tr_b16 v[98:99], v124 offset:0
    ds_read_b64_tr_b16 v[100:101], v5 offset:0
    ds_read_b64_tr_b16 v[102:103], v125 offset:0
    s_waitcnt vmcnt(8) lgkmcnt(4)
    v_mfma_f32_32x32x16_bf16 v[16:31], v[104:107], v[76:79], v[16:31]
    v_mfma_f32_32x32x16_bf16 v[32:47], v[108:111], v[76:79], v[32:47]
    ds_read_b64_tr_b16 v[104:105], v4 offset:2048
    ds_read_b64_tr_b16 v[106:107], v124 offset:2048
    ds_read_b64_tr_b16 v[108:109], v5 offset:2048
    ds_read_b64_tr_b16 v[110:111], v125 offset:2048
    s_waitcnt vmcnt(7) lgkmcnt(4)
    v_mfma_f32_32x32x16_bf16 v[16:31], v[96:99], v[80:83], v[16:31]
    v_mfma_f32_32x32x16_bf16 v[32:47], v[100:103], v[80:83], v[32:47]
    ds_read_b64_tr_b16 v[96:97], v4 offset:4096
    ds_read_b64_tr_b16 v[98:99], v124 offset:4096
    ds_read_b64_tr_b16 v[100:101], v5 offset:4096
    ds_read_b64_tr_b16 v[102:103], v125 offset:4096
    s_waitcnt vmcnt(6) lgkmcnt(4)
    v_mfma_f32_32x32x16_bf16 v[16:31], v[104:107], v[84:87], v[16:31]
    v_mfma_f32_32x32x16_bf16 v[32:47], v[108:111], v[84:87], v[32:47]
    ds_read_b64_tr_b16 v[104:105], v4 offset:6144
    ds_read_b64_tr_b16 v[106:107], v124 offset:6144
    ds_read_b64_tr_b16 v[108:109], v5 offset:6144
    ds_read_b64_tr_b16 v[110:111], v125 offset:6144
    s_waitcnt vmcnt(5) lgkmcnt(4)
    v_mfma_f32_32x32x16_bf16 v[16:31], v[96:99], v[88:91], v[16:31]
    v_mfma_f32_32x32x16_bf16 v[32:47], v[100:103], v[88:91], v[32:47]
    ds_read_b64_tr_b16 v[96:97], v4 offset:8192
    ds_read_b64_tr_b16 v[98:99], v124 offset:8192
    ds_read_b64_tr_b16 v[100:101], v5 offset:8192
    ds_read_b64_tr_b16 v[102:103], v125 offset:8192
    s_waitcnt vmcnt(4) lgkmcnt(4)
    v_mfma_f32_32x32x16_bf16 v[16:31], v[104:107], v[92:95], v[16:31]
    v_mfma_f32_32x32x16_bf16 v[32:47], v[108:111], v[92:95], v[32:47]
    ds_read_b64_tr_b16 v[104:105], v4 offset:10240
    ds_read_b64_tr_b16 v[106:107], v124 offset:10240
    ds_read_b64_tr_b16 v[108:109], v5 offset:10240
    ds_read_b64_tr_b16 v[110:111], v125 offset:10240
    s_waitcnt vmcnt(3) lgkmcnt(4)
    v_mfma_f32_32x32x16_bf16 v[16:31], v[96:99], v[48:51], v[16:31]
    v_mfma_f32_32x32x16_bf16 v[32:47], v[100:103], v[48:51], v[32:47]
    ds_read_b64_tr_b16 v[96:97], v4 offset:12288
    ds_read_b64_tr_b16 v[98:99], v124 offset:12288
    ds_read_b64_tr_b16 v[100:101], v5 offset:12288
    ds_read_b64_tr_b16 v[102:103], v125 offset:12288
    s_waitcnt vmcnt(2) lgkmcnt(4)
    v_mfma_f32_32x32x16_bf16 v[16:31], v[104:107], v[52:55], v[16:31]
    v_mfma_f32_32x32x16_bf16 v[32:47], v[108:111], v[52:55], v[32:47]
    ds_read_b64_tr_b16 v[104:105], v4 offset:14336
    ds_read_b64_tr_b16 v[106:107], v124 offset:14336
    ds_read_b64_tr_b16 v[108:109], v5 offset:14336
    ds_read_b64_tr_b16 v[110:111], v125 offset:14336
    s_waitcnt vmcnt(1) lgkmcnt(4)
    v_mfma_f32_32x32x16_bf16 v[16:31], v[96:99], v[56:59], v[16:31]
    v_mfma_f32_32x32x16_bf16 v[32:47], v[100:103], v[56:59], v[32:47]
    s_waitcnt vmcnt(0) lgkmcnt(0)
    v_mfma_f32_32x32x16_bf16 v[16:31], v[104:107], v[60:63], v[16:31]
    v_mfma_f32_32x32x16_bf16 v[32:47], v[108:111], v[60:63], v[32:47]
    s_nop 10
    v_pk_mul_f32 v[16:17], v[16:17], s[48:49]
    v_pk_mul_f32 v[18:19], v[18:19], s[48:49]
    v_pk_mul_f32 v[20:21], v[20:21], s[48:49]
    v_pk_mul_f32 v[22:23], v[22:23], s[48:49]
    v_cvt_pk_bf16_f32 v16, v16, v17
    v_cvt_pk_bf16_f32 v17, v18, v19
    v_cvt_pk_bf16_f32 v18, v20, v21
    v_cvt_pk_bf16_f32 v19, v22, v23
    s_bitcmp0_b32 s51, 0
    s_cbranch_scc1 L_qr6
    s_nop 0
    v_mov_b32_dpp v20, v16 quad_perm:[1,0,3,2] row_mask:0xf bank_mask:0xf
    v_mov_b32_dpp v21, v17 quad_perm:[1,0,3,2] row_mask:0xf bank_mask:0xf
    v_mov_b32_dpp v22, v18 quad_perm:[1,0,3,2] row_mask:0xf bank_mask:0xf
    v_mov_b32_dpp v23, v19 quad_perm:[1,0,3,2] row_mask:0xf bank_mask:0xf
    v_cndmask_b32 v18, v18, v20, s[64:65]
    v_cndmask_b32 v19, v19, v21, s[64:65]
    v_cndmask_b32 v16, v16, v22, s[66:67]
    v_cndmask_b32 v17, v17, v23, s[66:67]
L_qr6:
    buffer_store_dwordx4 v[16:19], v112, s[32:35], 0 offen sc1
    v_pk_mul_f32 v[24:25], v[24:25], s[48:49]
    v_pk_mul_f32 v[26:27], v[26:27], s[48:49]
    v_pk_mul_f32 v[28:29], v[28:29], s[48:49]
    v_pk_mul_f32 v[30:31], v[30:31], s[48:49]
    v_cvt_pk_bf16_f32 v24, v24, v25
    v_cvt_pk_bf16_f32 v25, v26, v27
    v_cvt_pk_bf16_f32 v26, v28, v29
    v_cvt_pk_bf16_f32 v27, v30, v31
    s_bitcmp0_b32 s51, 1
    s_cbranch_scc1 L_qr7
    s_nop 0
    v_mov_b32_dpp v28, v24 quad_perm:[1,0,3,2] row_mask:0xf bank_mask:0xf
    v_mov_b32_dpp v29, v25 quad_perm:[1,0,3,2] row_mask:0xf bank_mask:0xf
    v_mov_b32_dpp v30, v26 quad_perm:[1,0,3,2] row_mask:0xf bank_mask:0xf
    v_mov_b32_dpp v31, v27 quad_perm:[1,0,3,2] row_mask:0xf bank_mask:0xf
    v_cndmask_b32 v26, v26, v28, s[68:69]
    v_cndmask_b32 v27, v27, v29, s[68:69]
    v_cndmask_b32 v24, v24, v30, s[70:71]
    v_cndmask_b32 v25, v25, v31, s[70:71]
L_qr7:
    buffer_store_dwordx4 v[24:27], v115, s[32:35], 0 offen sc1
    v_pk_mul_f32 v[32:33], v[32:33], s[48:49]
    v_pk_mul_f32 v[34:35], v[34:35], s[48:49]
    v_pk_mul_f32 v[36:37], v[36:37], s[48:49]
    v_pk_mul_f32 v[38:39], v[38:39], s[48:49]
    v_cvt_pk_bf16_f32 v32, v32, v33
    v_cvt_pk_bf16_f32 v33, v34, v35
    v_cvt_pk_bf16_f32 v34, v36, v37
    v_cvt_pk_bf16_f32 v35, v38, v39
    s_bitcmp0_b32 s51, 2
    s_cbranch_scc1 L_qr8
    s_nop 0
    v_mov_b32_dpp v36, v32 quad_perm:[1,0,3,2] row_mask:0xf bank_mask:0xf
    v_mov_b32_dpp v37, v33 quad_perm:[1,0,3,2] row_mask:0xf bank_mask:0xf
    v_mov_b32_dpp v38, v34 quad_perm:[1,0,3,2] row_mask:0xf bank_mask:0xf
    v_mov_b32_dpp v39, v35 quad_perm:[1,0,3,2] row_mask:0xf bank_mask:0xf
    v_cndmask_b32 v34, v34, v36, s[72:73]
    v_cndmask_b32 v35, v35, v37, s[72:73]
    v_cndmask_b32 v32, v32, v38, s[74:75]
    v_cndmask_b32 v33, v33, v39, s[74:75]
L_qr8:
    buffer_store_dwordx4 v[32:35], v118, s[32:35], 0 offen sc1
    v_pk_mul_f32 v[40:41], v[40:41], s[48:49]
    v_pk_mul_f32 v[42:43], v[42:43], s[48:49]
    v_pk_mul_f32 v[44:45], v[44:45], s[48:49]
    v_pk_mul_f32 v[46:47], v[46:47], s[48:49]
    v_cvt_pk_bf16_f32 v40, v40, v41
    v_cvt_pk_bf16_f32 v41, v42, v43
    v_cvt_pk_bf16_f32 v42, v44, v45
    v_cvt_pk_bf16_f32 v43, v46, v47
    s_bitcmp0_b32 s51, 3
    s_cbranch_scc1 L_qr9
    s_nop 0
    v_mov_b32_dpp v44, v40 quad_perm:[1,0,3,2] row_mask:0xf bank_mask:0xf
    v_mov_b32_dpp v45, v41 quad_perm:[1,0,3,2] row_mask:0xf bank_mask:0xf
    v_mov_b32_dpp v46, v42 quad_perm:[1,0,3,2] row_mask:0xf bank_mask:0xf
    v_mov_b32_dpp v47, v43 quad_perm:[1,0,3,2] row_mask:0xf bank_mask:0xf
    v_cndmask_b32 v42, v42, v44, s[76:77]
    v_cndmask_b32 v43, v43, v45, s[76:77]
    v_cndmask_b32 v40, v40, v46, s[78:79]
    v_cndmask_b32 v41, v41, v47, s[78:79]
L_qr9:
    buffer_store_dwordx4 v[40:43], v121, s[32:35], 0 offen sc1
    s_branch L_qkv_done
L_qkv_V:
    v_and_b32 v11, 3, v2
    v_lshl_add_u32 v4, v11, 3, v8
    v_xor_b32 v5, 64, v4
    v_xor_b32 v124, 512, v4
    v_xor_b32 v125, 512, v5
    s_mul_i32 s45, s26, 2560
    s_add_u32 s45, s45, 5244160
    s_lshl_b32 s3, s27, 6
    v_add_u32 v10, s3, v10
    v_mul_u32_u24 v11, 320, v7
    v_add_u32 v11, s45, v11
    s_mov_b32 s44, 163840
    v_add_u32 v13, 0, v10
    v_mul_u32_u24 v14, 3277, v13
    v_lshrrev_b32 v14, 16, v14
    v_mul_u32_u24 v15, 20, v14
    v_sub_u32 v15, v13, v15
    v_lshl_add_u32 v3, v15, 4, v11
    v_mul_lo_u32 v14, v14, s44
    v_add_u32 v112, v3, v14
    v_add_u32 v13, 32, v10
    v_mul_u32_u24 v14, 3277, v13
    v_lshrrev_b32 v14, 16, v14
    v_mul_u32_u24 v15, 20, v14
    v_sub_u32 v15, v13, v15
    v_lshl_add_u32 v3, v15, 4, v11
    v_mul_lo_u32 v14, v14, s44
    v_add_u32 v113, v3, v14
    s_cmp_lg_u32 s25, 7
    s_cbranch_scc1 L_w210
    s_waitcnt vmcnt(0)
    v_cmp_ne_u64 vcc, s[60:61], v[126:127]
    s_cbranch_vccz L_w210
    s_mov_b64 exec, vcc
    s_mov_b32 s83, 0x40000
L_poll11_2:
    buffer_load_dwordx2 v[126:127], v0, s[32:35], 0 offen sc1
    s_waitcnt vmcnt(0)
    v_cmp_ne_u64 vcc, s[60:61], v[126:127]
    s_cbranch_vccz L_poll11_ok
    s_mov_b64 exec, vcc
    s_sleep 1
    s_sub_u32 s83, s83, 1
    s_cbranch_scc0 L_poll11_2
L_poll11_ok:
    s_mov_b64 exec, -1
L_w210:
    s_cmp_lt_u32 s25, 4
    s_cbranch_scc1 L_w210_a
    s_waitcnt vmcnt(0)
L_w210_a:
    s_barrier
    buffer_load_dwordx4 v[48:51], v9, s[32:35], s40 offen offset:0 sc1
    buffer_load_dwordx4 v[52:55], v9, s[32:35], s40 offen offset:1024 sc1
    buffer_load_dwordx4 v[56:59], v9, s[32:35], s40 offen offset:2048 sc1
    buffer_load_dwordx4 v[60:63], v9, s[32:35], s40 offen offset:3072 sc1
    s_add_u32 s40, s40, 4096
    ds_read_b64_tr_b16 v[96:97], v4 offset:0
    ds_read_b64_tr_b16 v[98:99], v124 offset:0
    ds_read_b64_tr_b16 v[100:101], v5 offset:0
    ds_read_b64_tr_b16 v[102:103], v125 offset:0
    ds_read_b64_tr_b16 v[104:105], v4 offset:2048
    ds_read_b64_tr_b16 v[106:107], v124 offset:2048
    ds_read_b64_tr_b16 v[108:109], v5 offset:2048
    ds_read_b64_tr_b16 v[110:111], v125 offset:2048
    s_waitcnt vmcnt(3) lgkmcnt(4)
    v_mfma_f32_32x32x16_bf16 v[16:31], v[48:51], v[96:99], v[16:31]
    v_mfma_f32_32x32x16_bf16 v[32:47], v[48:51], v[100:103], v[32:47]
    buffer_load_dwordx4 v[64:67], v9, s[32:35], s40 offen offset:0 sc1
    buffer_load_dwordx4 v[68:71], v9, s[32:35], s40 offen offset:1024 sc1
    ds_read_b64_tr_b16 v[96:97], v4 offset:4096
    ds_read_b64_tr_b16 v[98:99], v124 offset:4096
    ds_read_b64_tr_b16 v[100:101], v5 offset:4096
    ds_read_b64_tr_b16 v[102:103], v125 offset:4096
    s_waitcnt vmcnt(4) lgkmcnt(4)
    v_mfma_f32_32x32x16_bf16 v[16:31], v[52:55], v[104:107], v[16:31]
    v_mfma_f32_32x32x16_bf16 v[32:47], v[52:55], v[108:111], v[32:47]
    buffer_load_dwordx4 v[72:75], v9, s[32:35], s40 offen offset:2048 sc1
    buffer_load_dwordx4 v[76:79], v9, s[32:35], s40 offen offset:3072 sc1
    s_add_u32 s40, s40, 4096
    ds_read_b64_tr_b16 v[104:105], v4 offset:6144
    ds_read_b64_tr_b16 v[106:107], v124 offset:6144
    ds_read_b64_tr_b16 v[108:109], v5 offset:6144
    ds_read_b64_tr_b16 v[110:111], v125 offset:6144
    s_waitcnt vmcnt(5) lgkmcnt(4)
    v_mfma_f32_32x32x16_bf16 v[16:31], v[56:59], v[96:99], v[16:31]
    v_mfma_f32_32x32x16_bf16 v[32:47], v[56:59], v[100:103], v[32:47]
    buffer_load_dwordx4 v[80:83], v9, s[32:35], s40 offen offset:0 sc1
    buffer_load_dwordx4 v[84:87], v9, s[32:35], s40 offen offset:1024 sc1
    ds_read_b64_tr_b16 v[96:97], v4 offset:8192
    ds_read_b64_tr_b16 v[98:99], v124 offset:8192
    ds_read_b64_tr_b16 v[100:101], v5 offset:8192
    ds_read_b64_tr_b16 v[102:103], v125 offset:8192
    s_waitcnt vmcnt(6) lgkmcnt(4)
    v_mfma_f32_32x32x16_bf16 v[16:31], v[60:63], v[104:107], v[16:31]
    v_mfma_f32_32x32x16_bf16 v[32:47], v[60:63], v[108:111], v[32:47]
    buffer_load_dwordx4 v[88:91], v9, s[32:35], s40 offen offset:2048 sc1
    buffer_load_dwordx4 v[92:95], v9, s[32:35], s40 offen offset:3072 sc1
    s_add_u32 s40, s40, 4096
    ds_read_b64_tr_b16 v[104:105], v4 offset:10240
    ds_read_b64_tr_b16 v[106:107], v124 offset:10240
    ds_read_b64_tr_b16 v[108:109], v5 offset:10240
    ds_read_b64_tr_b16 v[110:111], v125 offset:10240
    s_waitcnt vmcnt(7) lgkmcnt(4)
    v_mfma_f32_32x32x16_bf16 v[16:31], v[64:67], v[96:99], v[16:31]
    v_mfma_f32_32x32x16_bf16 v[32:47], v[64:67], v[100:103], v[32:47]
    buffer_load_dwordx4 v[48:51], v9, s[32:35], s40 offen offset:0 sc1
    buffer_load_dwordx4 v[52:55], v9, s[32:35], s40 offen offset:1024 sc1
    ds_read_b64_tr_b16 v[96:97], v4 offset:12288
    ds_read_b64_tr_b16 v[98:99], v124 offset:12288
    ds_read_b64_tr_b16 v[100:101], v5 offset:12288
    ds_read_b64_tr_b16 v[102:103], v125 offset:12288
    s_waitcnt vmcnt(8) lgkmcnt(4)
    v_mfma_f32_32x32x16_bf16 v[16:31], v[68:71], v[104:107], v[16:31]
    v_mfma_f32_32x32x16_bf16 v[32:47], v[68:71], v[108:111], v[32:47]
    buffer_load_dwordx4 v[56:59], v9, s[32:35], s40 offen offset:2048 sc1
    buffer_load_dwordx4 v[60:63], v9, s[32:35], s40 offen offset:3072 sc1
    s_add_u32 s40, s40, 4096
    ds_read_b64_tr_b16 v[104:105], v4 offset:14336
    ds_read_b64_tr_b16 v[106:107], v124 offset:14336
    ds_read_b64_tr_b16 v[108:109], v5 offset:14336
    ds_read_b64_tr_b16 v[110:111], v125 offset:14336
    s_waitcnt vmcnt(9) lgkmcnt(4)
    v_mfma_f32_32x32x16_bf16 v[16:31], v[72:75], v[96:99], v[16:31]
    v_mfma_f32_32x32x16_bf16 v[32:47], v[72:75], v[100:103], v[32:47]
    buffer_load_dwordx4 v[64:67], v9, s[32:35], s40 offen offset:0 sc1
    buffer_load_dwordx4 v[68:71], v9, s[32:35], s40 offen offset:1024 sc1
    ds_read_b64_tr_b16 v[96:97], v4 offset:16384
    ds_read_b64_tr_b16 v[98:99], v124 offset:16384
    ds_read_b64_tr_b16 v[100:101], v5 offset:16384
    ds_read_b64_tr_b16 v[102:103], v125 offset:16384
    s_waitcnt vmcnt(10) lgkmcnt(4)
    v_mfma_f32_32x32x16_bf16 v[16:31], v[76:79], v[104:107], v[16:31]
    v_mfma_f32_32x32x16_bf16 v[32:47], v[76:79], v[108:111], v[32:47]
    buffer_load_dwordx4 v[72:75], v9, s[32:35], s40 offen offset:2048 sc1
    buffer_load_dwordx4 v[76:79], v9, s[32:35], s40 offen offset:3072 sc1
    s_add_u32 s40, s40, 4096
    ds_read_b64_tr_b16 v[104:105], v4 offset:18432
    ds_read_b64_tr_b16 v[106:107], v124 offset:18432
    ds_read_b64_tr_b16 v[108:109], v5 offset:18432
    ds_read_b64_tr_b16 v[110:111], v125 offset:18432
    s_waitcnt vmcnt(11) lgkmcnt(4)
    v_mfma_f32_32x32x16_bf16 v[16:31], v[80:83], v[96:99], v[16:31]
    v_mfma_f32_32x32x16_bf16 v[32:47], v[80:83], v[100:103], v[32:47]
    buffer_load_dwordx4 v[80:83], v9, s[32:35], s40 offen offset:0 sc1
    ds_read_b64_tr_b16 v[96:97], v4 offset:20480
    ds_read_b64_tr_b16 v[98:99], v124 offset:20480
    ds_read_b64_tr_b16 v[100:101], v5 offset:20480
    ds_read_b64_tr_b16 v[102:103], v125 offset:20480
    s_waitcnt vmcnt(11) lgkmcnt(4)
    v_mfma_f32_32x32x16_bf16 v[16:31], v[84:87], v[104:107], v[16:31]
    v_mfma_f32_32x32x16_bf16 v[32:47], v[84:87], v[108:111], v[32:47]
    buffer_load_dwordx4 v[84:87], v9, s[32:35], s40 offen offset:1024 sc1
    ds_read_b64_tr_b16 v[104:105], v4 offset:22528
    ds_read_b64_tr_b16 v[106:107], v124 offset:22528
    ds_read_b64_tr_b16 v[108:109], v5 offset:22528
    ds_read_b64_tr_b16 v[110:111], v125 offset:22528
    s_waitcnt vmcnt(11) lgkmcnt(4)
    v_mfma_f32_32x32x16_bf16 v[16:31], v[88:91], v[96:99], v[16:31]
    v_mfma_f32_32x32x16_bf16 v[32:47], v[88:91], v[100:103], v[32:47]
    buffer_load_dwordx4 v[88:91], v9, s[32:35], s40 offen offset:2048 sc1
    ds_read_b64_tr_b16 v[96:97], v4 offset:24576
    ds_read_b64_tr_b16 v[98:99], v124 offset:24576
    ds_read_b64_tr_b16 v[100:101], v5 offset:24576
    ds_read_b64_tr_b16 v[102:103], v125 offset:24576
    s_waitcnt vmcnt(11) lgkmcnt(4)
    v_mfma_f32_32x32x16_bf16 v[16:31], v[92:95], v[104:107], v[16:31]
    v_mfma_f32_32x32x16_bf16 v[32:47], v[92:95], v[108:111], v[32:47]
    buffer_load_dwordx4 v[92:95], v9, s[32:35], s40 offen offset:3072 sc1
    s_add_u32 s40, s40, 4096
    ds_read_b64_tr_b16 v[104:105], v4 offset:26624
    ds_read_b64_tr_b16 v[106:107], v124 offset:26624
    ds_read_b64_tr_b16 v[108:109], v5 offset:26624
    ds_read_b64_tr_b16 v[110:111], v125 offset:26624
    s_waitcnt vmcnt(11) lgkmcnt(4)
    v_mfma_f32_32x32x16_bf16 v[16:31], v[48:51], v[96:99], v[16:31]
    v_mfma_f32_32x32x16_bf16 v[32:47], v[48:51], v[100:103], v[32:47]
    buffer_load_dwordx4 v[48:51], v9, s[32:35], s40 offen offset:0 sc1
    ds_read_b64_tr_b16 v[96:97], v4 offset:28672
    ds_read_b64_tr_b16 v[98:99], v124 offset:28672
    ds_read_b64_tr_b16 v[100:101], v5 offset:28672
    ds_read_b64_tr_b16 v[102:103], v125 offset:28672
    s_waitcnt vmcnt(11) lgkmcnt(4)
    v_mfma_f32_32x32x16_bf16 v[16:31], v[52:55], v[104:107], v[16:31]
    v_mfma_f32_32x32x16_bf16 v[32:47], v[52:55], v[108:111], v[32:47]
    buffer_load_dwordx4 v[52:55], v9, s[32:35], s40 offen offset:1024 sc1
    ds_read_b64_tr_b16 v[104:105], v4 offset:30720
    ds_read_b64_tr_b16 v[106:107], v124 offset:30720
    ds_read_b64_tr_b16 v[108:109], v5 offset:30720
    ds_read_b64_tr_b16 v[110:111], v125 offset:30720
    s_waitcnt vmcnt(11) lgkmcnt(4)
    v_mfma_f32_32x32x16_bf16 v[16:31], v[56:59], v[96:99], v[16:31]
    v_mfma_f32_32x32x16_bf16 v[32:47], v[56:59], v[100:103], v[32:47]
    buffer_load_dwordx4 v[56:59], v9, s[32:35], s40 offen offset:2048 sc1
    ds_read_b64_tr_b16 v[96:97], v4 offset:32768
    ds_read_b64_tr_b16 v[98:99], v124 offset:32768
    ds_read_b64_tr_b16 v[100:101], v5 offset:32768
    ds_read_b64_tr_b16 v[102:103], v125 offset:32768
    s_waitcnt vmcnt(11) lgkmcnt(4)
    v_mfma_f32_32x32x16_bf16 v[16:31], v[60:63], v[104:107], v[16:31]
    v_mfma_f32_32x32x16_bf16 v[32:47], v[60:63], v[108:111], v[32:47]
    buffer_load_dwordx4 v[60:63], v9, s[32:35], s40 offen offset:3072 sc1
    s_add_u32 s40, s40, 4096
    ds_read_b64_tr_b16 v[104:105], v4 offset:34816
    ds_read_b64_tr_b16 v[106:107], v124 offset:34816
    ds_read_b64_tr_b16 v[108:109], v5 offset:34816
    ds_read_b64_tr_b16 v[110:111], v125 offset:34816
    s_waitcnt vmcnt(11) lgkmcnt(4)
    v_mfma_f32_32x32x16_bf16 v[16:31], v[64:67], v[96:99], v[16:31]
    v_mfma_f32_32x32x16_bf16 v[32:47], v[64:67], v[100:103], v[32:47]
    buffer_load_dwordx4 v[64:67], v9, s[32:35], s40 offen offset:0 sc1
    ds_read_b64_tr_b16 v[96:97], v4 offset:36864
    ds_read_b64_tr_b16 v[98:99], v124 offset:36864
    ds_read_b64_tr_b16 v[100:101], v5 offset:36864
    ds_read_b64_tr_b16 v[102:103], v125 offset:36864
    s_waitcnt vmcnt(11) lgkmcnt(4)
    v_mfma_f32_32x32x16_bf16 v[16:31], v[68:71], v[104:107], v[16:31]
    v_mfma_f32_32x32x16_bf16 v[32:47], v[68:71], v[108:111], v[32:47]
    buffer_load_dwordx4 v[68:71], v9, s[32:35], s40 offen offset:1024 sc1
    ds_read_b64_tr_b16 v[104:105], v4 offset:38912
    ds_read_b64_tr_b16 v[106:107], v124 offset:38912
    ds_read_b64_tr_b16 v[108:109], v5 offset:38912
    ds_read_b64_tr_b16 v[110:111], v125 offset:38912
    s_waitcnt vmcnt(11) lgkmcnt(4)
    v_mfma_f32_32x32x16_bf16 v[16:31], v[72:75], v[96:99], v[16:31]
    v_mfma_f32_32x32x16_bf16 v[32:47], v[72:75], v[100:103], v[32:47]
    buffer_load_dwordx4 v[72:75], v9, s[32:35], s40 offen offset:2048 sc1
    ds_read_b64_tr_b16 v[96:97], v4 offset:40960
    ds_read_b64_tr_b16 v[98:99], v124 offset:40960
    ds_read_b64_tr_b16 v[100:101], v5 offset:40960
    ds_read_b64_tr_b16 v[102:103], v125 offset:40960
    s_waitcnt vmcnt(11) lgkmcnt(4)
    v_mfma_f32_32x32x16_bf16 v[16:31], v[76:79], v[104:107], v[16:31]
    v_mfma_f32_32x32x16_bf16 v[32:47], v[76:79], v[108:111], v[32:47]
    buffer_load_dwordx4 v[76:79], v9, s[32:35], s40 offen offset:3072 sc1
    s_add_u32 s40, s40, 4096
    ds_read_b64_tr_b16 v[104:105], v4 offset:43008
    ds_read_b64_tr_b16 v[106:107], v124 offset:43008
    ds_read_b64_tr_b16 v[108:109], v5 offset:43008
    ds_read_b64_tr_b16 v[110:111], v125 offset:43008
    s_waitcnt vmcnt(11) lgkmcnt(4)
    v_mfma_f32_32x32x16_bf16 v[16:31], v[80:83], v[96:99], v[16:31]
    v_mfma_f32_32x32x16_bf16 v[32:47], v[80:83], v[100:103], v[32:47]
    buffer_load_dwordx4 v[80:83], v9, s[32:35], s40 offen offset:0 sc1
    ds_read_b64_tr_b16 v[96:97], v4 offset:45056
    ds_read_b64_tr_b16 v[98:99], v124 offset:45056
    ds_read_b64_tr_b16 v[100:101], v5 offset:45056
    ds_read_b64_tr_b16 v[102:103], v125 offset:45056
    s_waitcnt vmcnt(11) lgkmcnt(4)
    v_mfma_f32_32x32x16_bf16 v[16:31], v[84:87], v[104:107], v[16:31]
    v_mfma_f32_32x32x16_bf16 v[32:47], v[84:87], v[108:111], v[32:47]
    buffer_load_dwordx4 v[84:87], v9, s[32:35], s40 offen offset:1024 sc1
    ds_read_b64_tr_b16 v[104:105], v4 offset:47104
    ds_read_b64_tr_b16 v[106:107], v124 offset:47104
    ds_read_b64_tr_b16 v[108:109], v5 offset:47104
    ds_read_b64_tr_b16 v[110:111], v125 offset:47104
    s_waitcnt vmcnt(11) lgkmcnt(4)
    v_mfma_f32_32x32x16_bf16 v[16:31], v[88:91], v[96:99], v[16:31]
    v_mfma_f32_32x32x16_bf16 v[32:47], v[88:91], v[100:103], v[32:47]
    buffer_load_dwordx4 v[88:91], v9, s[32:35], s40 offen offset:2048 sc1
    ds_read_b64_tr_b16 v[96:97], v4 offset:49152
    ds_read_b64_tr_b16 v[98:99], v124 offset:49152
    ds_read_b64_tr_b16 v[100:101], v5 offset:49152
    ds_read_b64_tr_b16 v[102:103], v125 offset:49152
    s_waitcnt vmcnt(11) lgkmcnt(4)
    v_mfma_f32_32x32x16_bf16 v[16:31], v[92:95], v[104:107], v[16:31]
    v_mfma_f32_32x32x16_bf16 v[32:47], v[92:95], v[108:111], v[32:47]
    buffer_load_dwordx4 v[92:95], v9, s[32:35], s40 offen offset:3072 sc1
    s_add_u32 s40, s40, 4096
    ds_read_b64_tr_b16 v[104:105], v4 offset:51200
    ds_read_b64_tr_b16 v[106:107], v124 offset:51200
    ds_read_b64_tr_b16 v[108:109], v5 offset:51200
    ds_read_b64_tr_b16 v[110:111], v125 offset:51200
    s_waitcnt vmcnt(11) lgkmcnt(4)
    v_mfma_f32_32x32x16_bf16 v[16:31], v[48:51], v[96:99], v[16:31]
    v_mfma_f32_32x32x16_bf16 v[32:47], v[48:51], v[100:103], v[32:47]
    buffer_load_dwordx4 v[48:51], v9, s[32:35], s40 offen offset:0 sc1
    ds_read_b64_tr_b16 v[96:97], v4 offset:53248
    ds_read_b64_tr_b16 v[98:99], v124 offset:53248
    ds_read_b64_tr_b16 v[100:101], v5 offset:53248
    ds_read_b64_tr_b16 v[102:103], v125 offset:53248
    s_waitcnt vmcnt(11) lgkmcnt(4)
    v_mfma_f32_32x32x16_bf16 v[16:31], v[52:55], v[104:107], v[16:31]
    v_mfma_f32_32x32x16_bf16 v[32:47], v[52:55], v[108:111], v[32:47]
    buffer_load_dwordx4 v[52:55], v9, s[32:35], s40 offen offset:1024 sc1
    ds_read_b64_tr_b16 v[104:105], v4 offset:55296
    ds_read_b64_tr_b16 v[106:107], v124 offset:55296
    ds_read_b64_tr_b16 v[108:109], v5 offset:55296
    ds_read_b64_tr_b16 v[110:111], v125 offset:55296
    s_waitcnt vmcnt(11) lgkmcnt(4)
    v_mfma_f32_32x32x16_bf16 v[16:31], v[56:59], v[96:99], v[16:31]
    v_mfma_f32_32x32x16_bf16 v[32:47], v[56:59], v[100:103], v[32:47]
    buffer_load_dwordx4 v[56:59], v9, s[32:35], s40 offen offset:2048 sc1
    ds_read_b64_tr_b16 v[96:97], v4 offset:57344
    ds_read_b64_tr_b16 v[98:99], v124 offset:57344
    ds_read_b64_tr_b16 v[100:101], v5 offset:57344
    ds_read_b64_tr_b16 v[102:103], v125 offset:57344
    s_waitcnt vmcnt(11) lgkmcnt(4)
    v_mfma_f32_32x32x16_bf16 v[16:31], v[60:63], v[104:107], v[16:31]
    v_mfma_f32_32x32x16_bf16 v[32:47], v[60:63], v[108:111], v[32:47]
    buffer_load_dwordx4 v[60:63], v9, s[32:35], s40 offen offset:3072 sc1
    s_add_u32 s40, s40, 4096
    ds_read_b64_tr_b16 v[104:105], v4 offset:59392
    ds_read_b64_tr_b16 v[106:107], v124 offset:59392
    ds_read_b64_tr_b16 v[108:109], v5 offset:59392
    ds_read_b64_tr_b16 v[110:111], v125 offset:59392
    s_waitcnt vmcnt(11) lgkmcnt(4)
    v_mfma_f32_32x32x16_bf16 v[16:31], v[64:67], v[96:99], v[16:31]
    v_mfma_f32_32x32x16_bf16 v[32:47], v[64:67], v[100:103], v[32:47]
    ds_read_b64_tr_b16 v[96:97], v4 offset:61440
    ds_read_b64_tr_b16 v[98:99], v124 offset:61440
    ds_read_b64_tr_b16 v[100:101], v5 offset:61440
    ds_read_b64_tr_b16 v[102:103], v125 offset:61440
    s_waitcnt vmcnt(10) lgkmcnt(4)
    v_mfma_f32_32x32x16_bf16 v[16:31], v[68:71], v[104:107], v[16:31]
    v_mfma_f32_32x32x16_bf16 v[32:47], v[68:71], v[108:111], v[32:47]
    ds_read_b64_tr_b16 v[104:105], v4 offset:63488
    ds_read_b64_tr_b16 v[106:107], v124 offset:63488
    ds_read_b64_tr_b16 v[108:109], v5 offset:63488
    ds_read_b64_tr_b16 v[110:111], v125 offset:63488
    s_waitcnt vmcnt(9) lgkmcnt(4)
    v_mfma_f32_32x32x16_bf16 v[16:31], v[72:75], v[96:99], v[16:31]
    v_mfma_f32_32x32x16_bf16 v[32:47], v[72:75], v[100:103], v[32:47]
    v_add_u32 v4, 0x10000, v4
    v_add_u32 v5, 0x10000, v5
    v_add_u32 v124, 0x10000, v124
    v_add_u32 v125, 0x10000, v125
    ds_read_b64_tr_b16 v[96:97], v4 offset:0
    ds_read_b64_tr_b16 v[98:99], v124 offset:0
    ds_read_b64_tr_b16 v[100:101], v5 offset:0
    ds_read_b64_tr_b16 v[102:103], v125 offset:0
    s_waitcnt vmcnt(8) lgkmcnt(4)
    v_mfma_f32_32x32x16_bf16 v[16:31], v[76:79], v[104:107], v[16:31]
    v_mfma_f32_32x32x16_bf16 v[32:47], v[76:79], v[108:111], v[32:47]
    ds_read_b64_tr_b16 v[104:105], v4 offset:2048
    ds_read_b64_tr_b16 v[106:107], v124 offset:2048
    ds_read_b64_tr_b16 v[108:109], v5 offset:2048
    ds_read_b64_tr_b16 v[110:111], v125 offset:2048
    s_waitcnt vmcnt(7) lgkmcnt(4)
    v_mfma_f32_32x32x16_bf16 v[16:31], v[80:83], v[96:99], v[16:31]
    v_mfma_f32_32x32x16_bf16 v[32:47], v[80:83], v[100:103], v[32:47]
    ds_read_b64_tr_b16 v[96:97], v4 offset:4096
    ds_read_b64_tr_b16 v[98:99], v124 offset:4096
    ds_read_b64_tr_b16 v[100:101], v5 offset:4096
    ds_read_b64_tr_b16 v[102:103], v125 offset:4096
    s_waitcnt vmcnt(6) lgkmcnt(4)
    v_mfma_f32_32x32x16_bf16 v[16:31], v[84:87], v[104:107], v[16:31]
    v_mfma_f32_32x32x16_bf16 v[32:47], v[84:87], v[108:111], v[32:47]
    ds_read_b64_tr_b16 v[104:105], v4 offset:6144
    ds_read_b64_tr_b16 v[106:107], v124 offset:6144
    ds_read_b64_tr_b16 v[108:109], v5 offset:6144
    ds_read_b64_tr_b16 v[110:111], v125 offset:6144
    s_waitcnt vmcnt(5) lgkmcnt(4)
    v_mfma_f32_32x32x16_bf16 v[16:31], v[88:91], v[96:99], v[16:31]
    v_mfma_f32_32x32x16_bf16 v[32:47], v[88:91], v[100:103], v[32:47]
    ds_read_b64_tr_b16 v[96:97], v4 offset:8192
    ds_read_b64_tr_b16 v[98:99], v124 offset:8192
    ds_read_b64_tr_b16 v[100:101], v5 offset:8192
    ds_read_b64_tr_b16 v[102:103], v125 offset:8192
    s_waitcnt vmcnt(4) lgkmcnt(4)
    v_mfma_f32_32x32x16_bf16 v[16:31], v[92:95], v[104:107], v[16:31]
    v_mfma_f32_32x32x16_bf16 v[32:47], v[92:95], v[108:111], v[32:47]
    ds_read_b64_tr_b16 v[104:105], v4 offset:10240
    ds_read_b64_tr_b16 v[106:107], v124 offset:10240
    ds_read_b64_tr_b16 v[108:109], v5 offset:10240
    ds_read_b64_tr_b16 v[110:111], v125 offset:10240
    s_waitcnt vmcnt(3) lgkmcnt(4)
    v_mfma_f32_32x32x16_bf16 v[16:31], v[48:51], v[96:99], v[16:31]
    v_mfma_f32_32x32x16_bf16 v[32:47], v[48:51], v[100:103], v[32:47]
    ds_read_b64_tr_b16 v[96:97], v4 offset:12288
    ds_read_b64_tr_b16 v[98:99], v124 offset:12288
    ds_read_b64_tr_b16 v[100:101], v5 offset:12288
    ds_read_b64_tr_b16 v[102:103], v125 offset:12288
    s_waitcnt vmcnt(2) lgkmcnt(4)
    v_mfma_f32_32x32x16_bf16 v[16:31], v[52:55], v[104:107], v[16:31]
    v_mfma_f32_32x32x16_bf16 v[32:47], v[52:55], v[108:111], v[32:47]
    ds_read_b64_tr_b16 v[104:105], v4 offset:14336
    ds_read_b64_tr_b16 v[106:107], v124 offset:14336
    ds_read_b64_tr_b16 v[108:109], v5 offset:14336
    ds_read_b64_tr_b16 v[110:111], v125 offset:14336
    s_waitcnt vmcnt(1) lgkmcnt(4)
    v_mfma_f32_32x32x16_bf16 v[16:31], v[56:59], v[96:99], v[16:31]
    v_mfma_f32_32x32x16_bf16 v[32:47], v[56:59], v[100:103], v[32:47]
    s_waitcnt vmcnt(0) lgkmcnt(0)
    v_mfma_f32_32x32x16_bf16 v[16:31], v[60:63], v[104:107], v[16:31]
    v_mfma_f32_32x32x16_bf16 v[32:47], v[60:63], v[108:111], v[32:47]
    s_nop 10
    v_cvt_pk_bf16_f32 v16, v16, v17
    v_cvt_pk_bf16_f32 v17, v18, v19
    v_cvt_pk_bf16_f32 v18, v20, v21
    v_cvt_pk_bf16_f32 v19, v22, v23
    buffer_store_dwordx4 v[16:19], v112, s[32:35], 0 offen offset:0 sc1
    v_cvt_pk_bf16_f32 v24, v24, v25
    v_cvt_pk_bf16_f32 v25, v26, v27
    v_cvt_pk_bf16_f32 v26, v28, v29
    v_cvt_pk_bf16_f32 v27, v30, v31
    buffer_store_dwordx4 v[24:27], v112, s[32:35], 0 offen offset:640 sc1
    v_cvt_pk_bf16_f32 v32, v32, v33
    v_cvt_pk_bf16_f32 v33, v34, v35
    v_cvt_pk_bf16_f32 v34, v36, v37
    v_cvt_pk_bf16_f32 v35, v38, v39
    buffer_store_dwordx4 v[32:35], v113, s[32:35], 0 offen offset:0 sc1
    v_cvt_pk_bf16_f32 v40, v40, v41
    v_cvt_pk_bf16_f32 v41, v42, v43
    v_cvt_pk_bf16_f32 v42, v44, v45
    v_cvt_pk_bf16_f32 v43, v46, v47
    buffer_store_dwordx4 v[40:43], v113, s[32:35], 0 offen offset:640 sc1
L_qkv_done:
    s_setprio 3
    s_waitcnt vmcnt(0)
    s_barrier
    s_cmp_lg_u32 s25, 0
    s_cbranch_scc1 L_w012
    s_lshl_b32 s62, s46, 7
    s_add_u32 s62, s62, 21037056
    v_mov_b32 v0, 0
    v_mov_b32 v10, s60
    v_mov_b32 v11, s61
    s_mov_b64 exec, 1
    buffer_store_dwordx2 v[10:11], v0, s[32:35], s62 offen sc1
    s_mov_b64 exec, -1
L_w012:
    s_cmp_lg_u32 s25, 0
    s_cbranch_scc1 L_w013
    s_lshl_b32 s62, s2, 7
    s_add_u32 s62, s62, 21102592
    v_mov_b32 v0, 0
    v_mov_b32 v10, s60
    v_mov_b32 v11, s61
    s_mov_b64 exec, 1
    buffer_store_dwordx2 v[10:11], v0, s[32:35], s62 offen sc1
    s_mov_b64 exec, -1
L_w013:
    s_branch L_a_attn
L_a_spare:
    s_cmp_lg_u32 s25, 0
    s_cbranch_scc1 L_w014
    s_and_b32 s63, s2, 7
    s_lshl_b32 s63, s63, 6
    v_and_b32 v12, 63, v2
    v_add_u32 v12, s63, v12
    v_lshlrev_b32 v12, 7, v12
    v_add_u32 v12, 20971520, v12
    s_mov_b32 s83, 0x40000
    s_mov_b64 exec, 1
L_poll15:
    buffer_load_dwordx2 v[10:11], v12, s[32:35], 0 offen sc1
    s_waitcnt vmcnt(0)
    v_cmp_ne_u64 vcc, s[60:61], v[10:11]
    s_cbranch_vccz L_poll15_1
    s_sleep 4
    s_sub_u32 s83, s83, 1
    s_cbranch_scc0 L_poll15
L_poll15_1:
    s_mov_b64 exec, -2
L_poll15_2:
    buffer_load_dwordx2 v[10:11], v12, s[32:35], 0 offen sc1
    s_waitcnt vmcnt(0)
    v_cmp_ne_u64 vcc, s[60:61], v[10:11]
    s_cbranch_vccz L_poll15_ok
    s_mov_b64 exec, vcc
    s_sleep 1
    s_sub_u32 s83, s83, 1
    s_cbranch_scc0 L_poll15_2
L_poll15_ok:
    s_mov_b64 exec, -1
L_w014:
    s_barrier
    s_cmp_ge_u32 s25, 4
    s_cselect_b32 s36, s14, s12
    s_cselect_b32 s37, s15, s13
    s_mov_b32 s38, 1966080
    s_mov_b32 s39, 0x00020000
    s_and_b32 s3, s25, 3
    s_sub_u32 s50, s2, 240
    s_lshl_b32 s50, s50, 2
    s_add_u32 s50, s50, s3
    s_lshl_b32 s50, s50, 10
    buffer_load_dwordx4 v[16:19], v9, s[36:39], s50 offen
    s_add_u32 s50, s50, 65536
    buffer_load_dwordx4 v[20:23], v9, s[36:39], s50 offen
    s_add_u32 s50, s50, 65536
    buffer_load_dwordx4 v[24:27], v9, s[36:39], s50 offen
    s_add_u32 s50, s50, 65536
    buffer_load_dwordx4 v[28:31], v9, s[36:39], s50 offen
    s_add_u32 s50, s50, 65536
    buffer_load_dwordx4 v[32:35], v9, s[36:39], s50 offen
    s_add_u32 s50, s50, 65536
    buffer_load_dwordx4 v[36:39], v9, s[36:39], s50 offen
    s_add_u32 s50, s50, 65536
    buffer_load_dwordx4 v[40:43], v9, s[36:39], s50 offen
    s_add_u32 s50, s50, 65536
    buffer_load_dwordx4 v[44:47], v9, s[36:39], s50 offen
    s_add_u32 s50, s50, 65536
    buffer_load_dwordx4 v[48:51], v9, s[36:39], s50 offen
    s_add_u32 s50, s50, 65536
    buffer_load_dwordx4 v[52:55], v9, s[36:39], s50 offen
    s_add_u32 s50, s50, 65536
    buffer_load_dwordx4 v[56:59], v9, s[36:39], s50 offen
    s_add_u32 s50, s50, 65536
    buffer_load_dwordx4 v[60:63], v9, s[36:39], s50 offen
    s_add_u32 s50, s50, 65536
    buffer_load_dwordx4 v[64:67], v9, s[36:39], s50 offen
    s_add_u32 s50, s50, 65536
    buffer_load_dwordx4 v[68:71], v9, s[36:39], s50 offen
    s_add_u32 s50, s50, 65536
    buffer_load_dwordx4 v[72:75], v9, s[36:39], s50 offen
    s_add_u32 s50, s50, 65536
    buffer_load_dwordx4 v[76:79], v9, s[36:39], s50 offen
    s_add_u32 s50, s50, 65536
    buffer_load_dwordx4 v[16:19], v9, s[36:39], s50 offen
    s_add_u32 s50, s50, 65536
    buffer_load_dwordx4 v[20:23], v9, s[36:39], s50 offen
    s_add_u32 s50, s50, 65536
    s_waitcnt vmcnt(0)
    s_setprio 3
L_a_attn:
    s_and_b32 s24, s2, 7
    s_lshr_b32 s27, s2, 3
    s_lshl_b32 s24, s24, 2
    s_lshr_b32 s3, s27, 3
    s_add_u32 s24, s24, s3
    s_and_b32 s27, s27, 7
    s_cmp_lg_u32 s25, 0
    s_cbranch_scc1 L_w016
    s_mul_i32 s3, s24, 20
    s_lshr_b32 s26, s3, 6
    s_add_u32 s3, s3, 19
    s_lshr_b32 s3, s3, 6
    s_sub_u32 s3, s3, s26
    v_min_u32 v10, 47, v2
    v_lshrrev_b32 v11, 4, v10
    v_mul_u32_u24 v11, 10, v11
    v_bfe_u32 v12, v10, 3, 1
    v_mul_lo_u32 v12, v12, s3
    v_add3_u32 v11, v11, v12, s26
    v_and_b32 v12, 7, v10
    v_mov_b32 v13, s27
    v_cmp_gt_u32 vcc, 16, v10
    s_nop 1
    v_cndmask_b32 v12, v12, v13, vcc
    v_lshl_add_u32 v14, v11, 3, v12
    v_lshlrev_b32 v14, 7, v14
    v_add_u32 v14, 21037056, v14
    s_mov_b32 s83, 0x40000
    s_mov_b64 exec, 1
L_poll17:
    buffer_load_dwordx2 v[10:11], v14, s[32:35], 0 offen sc1
    s_waitcnt vmcnt(0)
    v_cmp_ne_u64 vcc, s[60:61], v[10:11]
    s_cbranch_vccz L_poll17_1
    s_sleep 2
    s_sub_u32 s83, s83, 1
    s_cbranch_scc0 L_poll17
L_poll17_1:
    s_mov_b64 exec, -2
L_poll17_2:
    buffer_load_dwordx2 v[10:11], v14, s[32:35], 0 offen sc1
    s_waitcnt vmcnt(0)
    v_cmp_ne_u64 vcc, s[60:61], v[10:11]
    s_cbranch_vccz L_poll17_ok
    s_mov_b64 exec, vcc
    s_sleep 1
    s_sub_u32 s83, s83, 1
    s_cbranch_scc0 L_poll17_2
L_poll17_ok:
    s_mov_b64 exec, -1
L_w016:
    s_barrier
    s_and_b32 s46, s25, 3
    s_lshr_b32 s47, s25, 2
    s_lshl_b32 s26, s27, 3
    s_lshl_b32 s3, s46, 1
    s_add_u32 s26, s26, s3
    s_lshl_b32 s3, s24, 6
    s_add_u32 s3, s3, s26
    s_lshl_b32 s40, s3, 10
    s_add_u32 s40, s40, 2621440
    s_lshl_b32 s41, s3, 8
    s_add_u32 s41, s41, 4718592
    s_mul_i32 s42, s24, 163840
    s_add_u32 s42, s42, 5242880
    s_mul_i32 s3, s25, 5120
    s_add_u32 s43, s42, s3
    s_mov_b32 s44, s3
    v_and_b32 v6, 31, v2
    v_lshlrev_b32 v4, 3, v6
    buffer_load_dwordx4 v[88:91], v9, s[32:35], s40 offen sc1
    buffer_load_dwordx4 v[94:97], v9, s[32:35], s40 offen offset:1024 sc1
    v_mov_b32 v92, 0
    v_mov_b32 v93, 0
    v_mov_b32 v98, 0
    v_mov_b32 v99, 0
    v_mov_b32 v105, 0
    v_mov_b32 v111, 0
    s_mov_b32 exec_hi, 0
    buffer_load_dwordx2 v[92:93], v4, s[32:35], s41 offen sc1
    buffer_load_dwordx2 v[98:99], v4, s[32:35], s41 offen offset:256 sc1
    s_mov_b32 exec_hi, -1
    s_cmp_ge_u32 s25, 4
    s_cbranch_scc1 L_at_nodma0
    s_mov_b32 m0, s44
    s_add_u32 s50, s43, 4096
    buffer_load_dwordx4 v9, s[32:35], s43 offen sc1 lds
    buffer_load_dwordx4 v9, s[32:35], s43 offen offset:1024 sc1 lds
    buffer_load_dwordx4 v9, s[32:35], s43 offen offset:2048 sc1 lds
    buffer_load_dwordx4 v9, s[32:35], s43 offen offset:3072 sc1 lds
    s_add_u32 m0, s44, 4096
    s_add_u32 s43, s43, 20480
    buffer_load_dwordx4 v9, s[32:35], s50 offen sc1 lds
    s_add_u32 s44, s44, 20480
    s_mov_b32 m0, s44
    s_add_u32 s50, s43, 4096
    buffer_load_dwordx4 v9, s[32:35], s43 offen sc1 lds
    buffer_load_dwordx4 v9, s[32:35], s43 offen offset:1024 sc1 lds
    buffer_load_dwordx4 v9, s[32:35], s43 offen offset:2048 sc1 lds
    buffer_load_dwordx4 v9, s[32:35], s43 offen offset:3072 sc1 lds
    s_add_u32 m0, s44, 4096
    s_add_u32 s43, s43, 20480
    buffer_load_dwordx4 v9, s[32:35], s50 offen sc1 lds
    s_add_u32 s44, s44, 20480
    s_mov_b32 m0, s44
    s_add_u32 s50, s43, 4096
    buffer_load_dwordx4 v9, s[32:35], s43 offen sc1 lds
    buffer_load_dwordx4 v9, s[32:35], s43 offen offset:1024 sc1 lds
    buffer_load_dwordx4 v9, s[32:35], s43 offen offset:2048 sc1 lds
    buffer_load_dwordx4 v9, s[32:35], s43 offen offset:3072 sc1 lds
    s_add_u32 m0, s44, 4096
    s_add_u32 s43, s43, 20480
    buffer_load_dwordx4 v9, s[32:35], s50 offen sc1 lds
    s_add_u32 s44, s44, 20480
    s_sub_u32 s44, s44, 61440
L_at_nodma0:
    s_cmp_lg_u32 s25, 0
    s_cbranch_scc1 L_w018
    s_lshl_b32 s62, s2, 7
    s_add_u32 s62, s62, 21364736
    v_mov_b32 v0, 0
    v_mov_b32 v10, s60
    v_mov_b32 v11, s61
    s_mov_b64 exec, 1
    buffer_store_dwordx2 v[10:11], v0, s[32:35], s62 offen sc1
    s_mov_b64 exec, -1
L_w018:
    v_lshrrev_b32 v7, 5, v2
    v_mul_u32_u24 v5, 320, v7
    v_lshl_add_u32 v5, v6, 4, v5
    s_mov_b32 s30, 0x000fffff
    s_mov_b32 s31, 0x000fffff
    v_mov_b32 v104, 0x3f80
    v_mov_b32 v110, 0x3f80
    v_cmp_eq_u32 vcc, 20, v6
    v_mov_b32 v8, 0x3f803f80
    s_nop 0
    v_cndmask_b32 v8, 0, v8, vcc
    v_mov_b32 v112, v8
    v_mov_b32 v113, v8
    v_mov_b32 v114, v8
    v_mov_b32 v115, v8
    v_mov_b32 v116, v8
    v_mov_b32 v117, v8
    v_mov_b32 v118, v8
    v_mov_b32 v119, v8
    v_mov_b32 v120, v8
    v_mov_b32 v121, v8
    v_mov_b32 v122, v8
    v_mov_b32 v123, v8
    v_mov_b32 v124, v8
    v_mov_b32 v125, v8
    v_mov_b32 v126, v8
    v_mov_b32 v127, v8
    v_mov_b32 v52, 0
    v_mov_b32 v53, 0
    v_mov_b32 v54, 0
    v_mov_b32 v55, 0
    s_cmp_ge_u32 s25, 4
    s_cbranch_scc1 L_at_w0
    s_waitcnt vmcnt(10)
    s_branch L_at_w1
L_at_w0:
    s_waitcnt vmcnt(0)
L_at_w1:
    s_barrier
    s_mul_i32 s3, s47, 10240
    s_xor_b32 s50, s3, 10240
    v_add_u32 v10, s50, v9
    v_add_u32 v11, s50, v4
    v_add_u32 v3, s3, v9
    v_add_u32 v4, s3, v4
    v_add_u32 v5, s3, v5
    ds_read_b128 v[106:109], v10
    ds_read_b128 v[100:103], v3
    s_mov_b32 exec_hi, 0
    ds_read_b64 v[110:111], v11 offset:1024
    ds_read_b64 v[104:105], v4 offset:1024
    s_mov_b64 exec, s[30:31]
    ds_read_b128 v[112:115], v5 offset:1280
    ds_read_b128 v[116:119], v5 offset:1920
    s_mov_b64 exec, -1
    s_waitcnt lgkmcnt(2)
    v_mfma_f32_32x32x16_bf16 v[16:31], v[106:109], v[88:91], 0
    v_mfma_f32_32x32x8_bf16 v[16:31], v[110:111], v[92:93], v[16:31]
    v_mfma_f32_32x32x16_bf16 v[32:47], v[100:103], v[88:91], 0
    v_mfma_f32_32x32x8_bf16 v[32:47], v[104:105], v[92:93], v[32:47]
    v_mfma_f32_32x32x16_bf16 v[56:71], v[106:109], v[94:97], 0
    v_mfma_f32_32x32x8_bf16 v[56:71], v[110:111], v[98:99], v[56:71]
    v_mfma_f32_32x32x16_bf16 v[72:87], v[100:103], v[94:97], 0
    v_mfma_f32_32x32x8_bf16 v[72:87], v[104:105], v[98:99], v[72:87]
    s_nop 4
    v_cmp_lt_u32 vcc, 31, v2
    v_max3_f32 v10, v16, v17, v18
    v_max3_f32 v11, v19, v20, v21
    v_max3_f32 v10, v10, v22, v23
    v_max3_f32 v11, v11, v24, v25
    v_max3_f32 v10, v10, v26, v27
    v_max3_f32 v11, v11, v28, v29
    v_max3_f32 v10, v10, v30, v31
    v_max3_f32 v11, v11, v32, v33
    v_max3_f32 v10, v10, v34, v35
    v_max3_f32 v11, v11, v36, v37
    v_max3_f32 v10, v10, v38, v39
    v_max3_f32 v11, v11, v40, v41
    v_max3_f32 v10, v10, v42, v43
    v_max3_f32 v11, v11, v44, v45
    v_max3_f32 v10, v10, v46, v47
    v_max_f32 v10, v10, v11
    v_mov_b32 v11, v10
    s_nop 1
    v_permlane32_swap_b32 v10, v11
    v_max_f32 v10, v10, v11
    v_add_f32 v10, 0x42c00000, v10
    v_sub_f32 v10, 0, v10
    v_cvt_pk_bf16_f32 v10, v10, 0
    v_cndmask_b32 v92, v92, v10, vcc
    v_max3_f32 v12, v56, v57, v58
    v_max3_f32 v13, v59, v60, v61
    v_max3_f32 v12, v12, v62, v63
    v_max3_f32 v13, v13, v64, v65
    v_max3_f32 v12, v12, v66, v67
    v_max3_f32 v13, v13, v68, v69
    v_max3_f32 v12, v12, v70, v71
    v_max3_f32 v13, v13, v72, v73
    v_max3_f32 v12, v12, v74, v75
    v_max3_f32 v13, v13, v76, v77
    v_max3_f32 v12, v12, v78, v79
    v_max3_f32 v13, v13, v80, v81
    v_max3_f32 v12, v12, v82, v83
    v_max3_f32 v13, v13, v84, v85
    v_max3_f32 v12, v12, v86, v87
    v_max_f32 v12, v12, v13
    v_mov_b32 v13, v12
    s_nop 1
    v_permlane32_swap_b32 v12, v13
    v_max_f32 v12, v12, v13
    v_add_f32 v12, 0x42c00000, v12
    v_sub_f32 v12, 0, v12
    v_cvt_pk_bf16_f32 v12, v12, 0
    v_mfma_f32_32x32x16_bf16 v[16:31], v[100:103], v[88:91], 0
    v_mfma_f32_32x32x8_bf16 v[16:31], v[104:105], v[92:93], v[16:31]
    v_cndmask_b32 v98, v98, v12, vcc
    v_mov_b32 v56, 0
    v_mov_b32 v57, 0
    v_mov_b32 v58, 0
    v_mov_b32 v59, 0
    v_mov_b32 v60, 0
    v_mov_b32 v61, 0
    v_mov_b32 v62, 0
    v_mov_b32 v63, 0
    v_mov_b32 v64, 0
    v_mov_b32 v65, 0
    v_mov_b32 v66, 0
    v_mov_b32 v67, 0
    v_mov_b32 v68, 0
    v_mov_b32 v69, 0
    v_mov_b32 v70, 0
    v_mov_b32 v71, 0
    v_mov_b32 v72, 0
    v_mov_b32 v73, 0
    v_mov_b32 v74, 0
    v_mov_b32 v75, 0
    v_mov_b32 v76, 0
    v_mov_b32 v77, 0
    v_mov_b32 v78, 0
    v_mov_b32 v79, 0
    v_mov_b32 v80, 0
    v_mov_b32 v81, 0
    v_mov_b32 v82, 0
    v_mov_b32 v83, 0
    v_mov_b32 v84, 0
    v_mov_b32 v85, 0
    v_mov_b32 v86, 0
    v_mov_b32 v87, 0
    s_waitcnt lgkmcnt(0)
    s_mov_b32 s45, 8
    s_mov_b32 s48, 20480
    s_mov_b32 s49, 0
.p2align 6
L_at_loop:
    s_cmp_ge_u32 s25, 4
    s_cbranch_scc1 L_at_y0
    s_setprio 2
    s_branch L_at_y1
L_at_y0:
    s_setprio 3
L_at_y1:
    v_mfma_f32_32x32x16_bf16 v[32:47], v[100:103], v[94:97], 0
    v_exp_f32 v16, v16
    v_exp_f32 v17, v17
    v_exp_f32 v18, v18
    v_exp_f32 v19, v19
    v_cvt_pk_bf16_f32 v48, v16, v17
    v_cvt_pk_bf16_f32 v49, v18, v19
    v_mfma_f32_32x32x16_bf16 v[72:87], v[124:127], v[52:55], v[72:87]
    ds_read_b128 v[106:109], v3 offset:2560
    s_mov_b32 exec_hi, 0
    ds_read_b64 v[110:111], v4 offset:3584
    s_mov_b64 exec, s[30:31]
    ds_read_b128 v[120:123], v5 offset:3840
    ds_read_b128 v[124:127], v5 offset:4480
    s_mov_b64 exec, -1
    v_exp_f32 v20, v20
    v_exp_f32 v21, v21
    v_exp_f32 v22, v22
    v_exp_f32 v23, v23
    v_cvt_pk_bf16_f32 v50, v20, v21
    v_cvt_pk_bf16_f32 v51, v22, v23
    v_mfma_f32_32x32x8_bf16 v[32:47], v[104:105], v[98:99], v[32:47]
    v_exp_f32 v24, v24
    v_exp_f32 v25, v25
    v_exp_f32 v26, v26
    v_exp_f32 v27, v27
    v_exp_f32 v28, v28
    v_mfma_f32_32x32x16_bf16 v[56:71], v[112:115], v[48:51], v[56:71]
    v_exp_f32 v29, v29
    v_exp_f32 v30, v30
    v_exp_f32 v31, v31
    v_cvt_pk_bf16_f32 v52, v24, v25
    v_cvt_pk_bf16_f32 v53, v26, v27
    v_cvt_pk_bf16_f32 v54, v28, v29
    v_cvt_pk_bf16_f32 v55, v30, v31
    s_waitcnt lgkmcnt(0)
    v_mfma_f32_32x32x16_bf16 v[16:31], v[106:109], v[88:91], 0
    v_exp_f32 v32, v32
    v_exp_f32 v33, v33
    v_exp_f32 v34, v34
    v_exp_f32 v35, v35
    v_cvt_pk_bf16_f32 v48, v32, v33
    v_cvt_pk_bf16_f32 v49, v34, v35
    v_mfma_f32_32x32x16_bf16 v[56:71], v[116:119], v[52:55], v[56:71]
    v_exp_f32 v36, v36
    v_exp_f32 v37, v37
    v_exp_f32 v38, v38
    v_exp_f32 v39, v39
    v_cvt_pk_bf16_f32 v50, v36, v37
    v_cvt_pk_bf16_f32 v51, v38, v39
    v_mfma_f32_32x32x8_bf16 v[16:31], v[110:111], v[92:93], v[16:31]
    v_exp_f32 v40, v40
    v_exp_f32 v41, v41
    v_exp_f32 v42, v42
    v_exp_f32 v43, v43
    v_exp_f32 v44, v44
    v_mfma_f32_32x32x16_bf16 v[72:87], v[112:115], v[48:51], v[72:87]
    v_exp_f32 v45, v45
    v_exp_f32 v46, v46
    v_exp_f32 v47, v47
    v_cvt_pk_bf16_f32 v52, v40, v41
    v_cvt_pk_bf16_f32 v53, v42, v43
    v_cvt_pk_bf16_f32 v54, v44, v45
    v_cvt_pk_bf16_f32 v55, v46, v47
    v_mfma_f32_32x32x16_bf16 v[32:47], v[106:109], v[94:97], 0
    v_exp_f32 v16, v16
    v_exp_f32 v17, v17
    v_exp_f32 v18, v18
    v_exp_f32 v19, v19
    v_cvt_pk_bf16_f32 v48, v16, v17
    v_cvt_pk_bf16_f32 v49, v18, v19
    v_mfma_f32_32x32x16_bf16 v[72:87], v[116:119], v[52:55], v[72:87]
    ds_read_b128 v[100:103], v3 offset:5120
    s_mov_b32 exec_hi, 0
    ds_read_b64 v[104:105], v4 offset:6144
    s_mov_b64 exec, s[30:31]
    ds_read_b128 v[112:115], v5 offset:6400
    ds_read_b128 v[116:119], v5 offset:7040
    s_mov_b64 exec, -1
    v_exp_f32 v20, v20
    v_exp_f32 v21, v21
    v_exp_f32 v22, v22
    v_exp_f32 v23, v23
    v_cvt_pk_bf16_f32 v50, v20, v21
    v_cvt_pk_bf16_f32 v51, v22, v23
    v_mfma_f32_32x32x8_bf16 v[32:47], v[110:111], v[98:99], v[32:47]
    v_exp_f32 v24, v24
    v_exp_f32 v25, v25
    v_exp_f32 v26, v26
    v_exp_f32 v27, v27
    v_exp_f32 v28, v28
    v_mfma_f32_32x32x16_bf16 v[56:71], v[120:123], v[48:51], v[56:71]
    v_exp_f32 v29, v29
    v_exp_f32 v30, v30
    v_exp_f32 v31, v31
    v_cvt_pk_bf16_f32 v52, v24, v25
    v_cvt_pk_bf16_f32 v53, v26, v27
    v_cvt_pk_bf16_f32 v54, v28, v29
    v_cvt_pk_bf16_f32 v55, v30, v31
    s_waitcnt lgkmcnt(0)
    v_mfma_f32_32x32x16_bf16 v[16:31], v[100:103], v[88:91], 0
    v_exp_f32 v32, v32
    v_exp_f32 v33, v33
    v_exp_f32 v34, v34
    v_exp_f32 v35, v35
    v_cvt_pk_bf16_f32 v48, v32, v33
    v_cvt_pk_bf16_f32 v49, v34, v35
    v_mfma_f32_32x32x16_bf16 v[56:71], v[124:127], v[52:55], v[56:71]
    v_exp_f32 v36, v36
    v_exp_f32 v37, v37
    v_exp_f32 v38, v38
    v_exp_f32 v39, v39
    v_cvt_pk_bf16_f32 v50, v36, v37
    v_cvt_pk_bf16_f32 v51, v38, v39
    v_mfma_f32_32x32x8_bf16 v[16:31], v[104:105], v[92:93], v[16:31]
    v_exp_f32 v40, v40
    v_exp_f32 v41, v41
    v_exp_f32 v42, v42
    v_exp_f32 v43, v43
    v_exp_f32 v44, v44
    v_mfma_f32_32x32x16_bf16 v[72:87], v[120:123], v[48:51], v[72:87]
    v_exp_f32 v45, v45
    v_exp_f32 v46, v46
    v_exp_f32 v47, v47
    v_cvt_pk_bf16_f32 v52, v40, v41
    v_cvt_pk_bf16_f32 v53, v42, v43
    v_cvt_pk_bf16_f32 v54, v44, v45
    v_cvt_pk_bf16_f32 v55, v46, v47
    v_mfma_f32_32x32x16_bf16 v[32:47], v[100:103], v[94:97], 0
    v_exp_f32 v16, v16
    v_exp_f32 v17, v17
    v_exp_f32 v18, v18
    v_exp_f32 v19, v19
    v_cvt_pk_bf16_f32 v48, v16, v17
    v_cvt_pk_bf16_f32 v49, v18, v19
    v_mfma_f32_32x32x16_bf16 v[72:87], v[124:127], v[52:55], v[72:87]
    ds_read_b128 v[106:109], v3 offset:7680
    s_mov_b32 exec_hi, 0
    ds_read_b64 v[110:111], v4 offset:8704
    s_mov_b64 exec, s[30:31]
    ds_read_b128 v[120:123], v5 offset:8960
    ds_read_b128 v[124:127], v5 offset:9600
    s_mov_b64 exec, -1
    v_exp_f32 v20, v20
    v_exp_f32 v21, v21
    v_exp_f32 v22, v22
    v_exp_f32 v23, v23
    v_cvt_pk_bf16_f32 v50, v20, v21
    v_cvt_pk_bf16_f32 v51, v22, v23
    v_mfma_f32_32x32x8_bf16 v[32:47], v[104:105], v[98:99], v[32:47]
    v_exp_f32 v24, v24
    v_exp_f32 v25, v25
    v_exp_f32 v26, v26
    v_exp_f32 v27, v27
    v_exp_f32 v28, v28
    v_mfma_f32_32x32x16_bf16 v[56:71], v[112:115], v[48:51], v[56:71]
    v_exp_f32 v29, v29
    v_exp_f32 v30, v30
    v_exp_f32 v31, v31
    v_cvt_pk_bf16_f32 v52, v24, v25
    v_cvt_pk_bf16_f32 v53, v26, v27
    v_cvt_pk_bf16_f32 v54, v28, v29
    v_cvt_pk_bf16_f32 v55, v30, v31
    s_waitcnt lgkmcnt(0)
    v_mfma_f32_32x32x16_bf16 v[16:31], v[106:109], v[88:91], 0
    v_exp_f32 v32, v32
    v_exp_f32 v33, v33
    v_exp_f32 v34, v34
    v_exp_f32 v35, v35
    v_cvt_pk_bf16_f32 v48, v32, v33
    v_cvt_pk_bf16_f32 v49, v34, v35
    v_mfma_f32_32x32x16_bf16 v[56:71], v[116:119], v[52:55], v[56:71]
    v_exp_f32 v36, v36
    v_exp_f32 v37, v37
    v_exp_f32 v38, v38
    v_exp_f32 v39, v39
    v_cvt_pk_bf16_f32 v50, v36, v37
    v_cvt_pk_bf16_f32 v51, v38, v39
    v_mfma_f32_32x32x8_bf16 v[16:31], v[110:111], v[92:93], v[16:31]
    v_exp_f32 v40, v40
    v_exp_f32 v41, v41
    v_exp_f32 v42, v42
    v_exp_f32 v43, v43
    v_exp_f32 v44, v44
    v_mfma_f32_32x32x16_bf16 v[72:87], v[112:115], v[48:51], v[72:87]
    v_exp_f32 v45, v45
    v_exp_f32 v46, v46
    v_exp_f32 v47, v47
    v_cvt_pk_bf16_f32 v52, v40, v41
    v_cvt_pk_bf16_f32 v53, v42, v43
    v_cvt_pk_bf16_f32 v54, v44, v45
    v_cvt_pk_bf16_f32 v55, v46, v47
    s_cmp_eq_u32 s45, 8
    s_cbranch_scc1 L_at_first
    s_waitcnt vmcnt(0)
L_at_first:
    s_waitcnt vmcnt(5)
    s_barrier
    s_sub_u32 s3, s48, s49
    v_add_u32 v3, s3, v3
    v_add_u32 v4, s3, v4
    v_add_u32 v5, s3, v5
    s_mov_b32 s49, s48
    s_add_u32 s48, s48, 20480
    s_cmp_ge_u32 s48, 61440
    s_cselect_b32 s48, 0, s48
    s_cmp_ge_u32 s25, 4
    s_cbranch_scc1 L_at_young
    s_sub_u32 s50, s45, 3
    s_cmp_ge_u32 s50, 5
    s_cbranch_scc1 L_at_nodma1
    s_mov_b32 m0, s44
    s_add_u32 s50, s43, 4096
    buffer_load_dwordx4 v9, s[32:35], s43 offen sc1 lds
    buffer_load_dwordx4 v9, s[32:35], s43 offen offset:1024 sc1 lds
    buffer_load_dwordx4 v9, s[32:35], s43 offen offset:2048 sc1 lds
    buffer_load_dwordx4 v9, s[32:35], s43 offen offset:3072 sc1 lds
    s_add_u32 m0, s44, 4096
    s_add_u32 s43, s43, 20480
    buffer_load_dwordx4 v9, s[32:35], s50 offen sc1 lds
    s_add_u32 s44, s44, 20480
    s_cmp_ge_u32 s44, 61440
    s_cselect_b32 s50, 61440, 0
    s_sub_u32 s44, s44, s50
    s_branch L_at_nodma1
L_at_young:
    s_setprio 1
L_at_nodma1:
    v_mfma_f32_32x32x16_bf16 v[32:47], v[106:109], v[94:97], 0
    v_exp_f32 v16, v16
    v_exp_f32 v17, v17
    v_exp_f32 v18, v18
    v_exp_f32 v19, v19
    v_cvt_pk_bf16_f32 v48, v16, v17
    v_cvt_pk_bf16_f32 v49, v18, v19
    v_mfma_f32_32x32x16_bf16 v[72:87], v[116:119], v[52:55], v[72:87]
    ds_read_b128 v[100:103], v3 offset:0
    s_mov_b32 exec_hi, 0
    ds_read_b64 v[104:105], v4 offset:1024
    s_mov_b64 exec, s[30:31]
    ds_read_b128 v[112:115], v5 offset:1280
    ds_read_b128 v[116:119], v5 offset:1920
    s_mov_b64 exec, -1
    v_exp_f32 v20, v20
    v_exp_f32 v21, v21
    v_exp_f32 v22, v22
    v_exp_f32 v23, v23
    v_cvt_pk_bf16_f32 v50, v20, v21
    v_cvt_pk_bf16_f32 v51, v22, v23
    v_mfma_f32_32x32x8_bf16 v[32:47], v[110:111], v[98:99], v[32:47]
    v_exp_f32 v24, v24
    v_exp_f32 v25, v25
    v_exp_f32 v26, v26
    v_exp_f32 v27, v27
    v_exp_f32 v28, v28
    v_mfma_f32_32x32x16_bf16 v[56:71], v[120:123], v[48:51], v[56:71]
    v_exp_f32 v29, v29
    v_exp_f32 v30, v30
    v_exp_f32 v31, v31
    v_cvt_pk_bf16_f32 v52, v24, v25
    v_cvt_pk_bf16_f32 v53, v26, v27
    v_cvt_pk_bf16_f32 v54, v28, v29
    v_cvt_pk_bf16_f32 v55, v30, v31
    s_waitcnt lgkmcnt(0)
    v_mfma_f32_32x32x16_bf16 v[16:31], v[100:103], v[88:91], 0
    v_exp_f32 v32, v32
    v_exp_f32 v33, v33
    v_exp_f32 v34, v34
    v_exp_f32 v35, v35
    v_cvt_pk_bf16_f32 v48, v32, v33
    v_cvt_pk_bf16_f32 v49, v34, v35
    v_mfma_f32_32x32x16_bf16 v[56:71], v[124:127], v[52:55], v[56:71]
    v_exp_f32 v36, v36
    v_exp_f32 v37, v37
    v_exp_f32 v38, v38
    v_exp_f32 v39, v39
    v_cvt_pk_bf16_f32 v50, v36, v37
    v_cvt_pk_bf16_f32 v51, v38, v39
    v_mfma_f32_32x32x8_bf16 v[16:31], v[104:105], v[92:93], v[16:31]
    v_exp_f32 v40, v40
    v_exp_f32 v41, v41
    v_exp_f32 v42, v42
    v_exp_f32 v43, v43
    v_exp_f32 v44, v44
    v_mfma_f32_32x32x16_bf16 v[72:87], v[120:123], v[48:51], v[72:87]
    v_exp_f32 v45, v45
    v_exp_f32 v46, v46
    v_exp_f32 v47, v47
    v_cvt_pk_bf16_f32 v52, v40, v41
    v_cvt_pk_bf16_f32 v53, v42, v43
    v_cvt_pk_bf16_f32 v54, v44, v45
    v_cvt_pk_bf16_f32 v55, v46, v47
    s_sub_u32 s45, s45, 1
    s_cmp_lg_u32 s45, 0
    s_cbranch_scc1 L_at_loop
    v_mfma_f32_32x32x16_bf16 v[72:87], v[124:127], v[52:55], v[72:87]
    s_setprio 3
    s_lshl_b32 s3, s46, 12
    v_add_u32 v6, s3, v9
    v_add_u32 v7, 61440, v6
    s_cmp_eq_u32 s47, 0
    s_cbranch_scc1 L_at_x0
    ds_write_b128 v7, v[56:59] offset:0
    ds_write_b128 v7, v[60:63] offset:1024
    ds_write_b128 v7, v[64:67] offset:2048
    v_mov_b32 v7, v6
    v_mov_b32 v88, v94
    v_mov_b32 v89, v95
    v_mov_b32 v90, v96
    v_mov_b32 v91, v97
    v_mov_b32 v92, v98
    v_mov_b32 v93, v99
    s_nop 0
    v_mov_b32 v56, v72
    v_mov_b32 v57, v73
    v_mov_b32 v58, v74
    v_mov_b32 v59, v75
    v_mov_b32 v60, v76
    v_mov_b32 v61, v77
    v_mov_b32 v62, v78
    v_mov_b32 v63, v79
    v_mov_b32 v64, v80
    v_mov_b32 v65, v81
    v_mov_b32 v66, v82
    v_mov_b32 v67, v83
    s_branch L_at_x1
L_at_x0:
    s_nop 6
    ds_write_b128 v6, v[72:75] offset:0
    ds_write_b128 v6, v[76:79] offset:1024
    ds_write_b128 v6, v[80:83] offset:2048
L_at_x1:
    s_add_u32 s26, s26, s47
    s_waitcnt lgkmcnt(0)
    s_barrier
    ds_read_b128 v[32:35], v7 offset:0
    ds_read_b128 v[36:39], v7 offset:1024
    ds_read_b128 v[40:43], v7 offset:2048
    s_mov_b32 s51, 0
    s_mov_b32 s54, 0x0d800000
    s_mov_b32 s55, 0x7c800000
    s_mov_b32 s58, 0x7f800000
    s_waitcnt lgkmcnt(0)
    v_pk_add_f32 v[56:57], v[56:57], v[32:33]
    v_pk_add_f32 v[58:59], v[58:59], v[34:35]
    v_pk_add_f32 v[60:61], v[60:61], v[36:37]
    v_pk_add_f32 v[62:63], v[62:63], v[38:39]
    v_pk_add_f32 v[64:65], v[64:65], v[40:41]
    v_pk_add_f32 v[66:67], v[66:67], v[42:43]
L_at_fin:
    v_mov_b32 v8, v64
    v_mov_b32 v10, v64
    s_nop 1
    v_permlane32_swap_b32 v8, v10
    v_rcp_f32 v11, v10
    s_nop 0
    v_mul_f32 v16, v11, v56
    v_mul_f32 v17, v11, v57
    v_mul_f32 v18, v11, v58
    v_mul_f32 v19, v11, v59
    v_mul_f32 v20, v11, v60
    v_mul_f32 v21, v11, v61
    v_mul_f32 v22, v11, v62
    v_mul_f32 v23, v11, v63
    v_mul_f32 v24, v11, v64
    v_mul_f32 v25, v11, v65
    v_mul_f32 v26, v11, v66
    v_mul_f32 v27, v11, v67
L_at_store:
    v_cvt_pk_bf16_f32 v48, v16, v17
    v_cvt_pk_bf16_f32 v49, v18, v19
    v_cvt_pk_bf16_f32 v50, v20, v21
    v_cvt_pk_bf16_f32 v51, v22, v23
    v_cvt_pk_bf16_f32 v52, v24, v25
    v_cvt_pk_bf16_f32 v53, v26, v27
    s_mul_i32 s3, s26, 40
    s_add_u32 s50, s3, s24
    s_lshl_b32 s50, s50, 10
    s_add_u32 s50, s50, 16777216
    buffer_store_dwordx4 v[48:51], v9, s[32:35], s50 offen sc1
    s_lshr_b32 s50, s24, 2
    s_add_u32 s50, s50, s3
    s_add_u32 s50, s50, 32
    s_lshl_b32 s50, s50, 10
    s_and_b32 s3, s24, 1
    s_lshl_b32 s3, s3, 9
    s_add_u32 s50, s50, s3
    s_bfe_u32 s3, s24, 0x10001
    s_lshl_b32 s3, s3, 3
    s_add_u32 s50, s50, s3
    s_add_u32 s50, s50, 16777216
    s_mov_b32 exec_hi, 0
    buffer_store_dwordx2 v[52:53], v9, s[32:35], s50 offen sc1
    s_mov_b32 exec_hi, -1
    s_cmp_eq_u32 s51, 1
    s_cbranch_scc1 L_at_done
    v_add_f32 v12, |v16|, |v17|
    v_add_f32 v12, |v18|, v12
    v_add_f32 v12, |v19|, v12
    v_add_f32 v12, |v20|, v12
    v_add_f32 v12, |v21|, v12
    v_add_f32 v12, |v22|, v12
    v_add_f32 v12, |v23|, v12
    v_add_f32 v13, |v24|, |v25|
    v_add_f32 v13, |v26|, v13
    v_add_f32 v13, |v27|, v13
    v_cmp_gt_u32 vcc, 32, v2
    s_nop 1
    v_cndmask_b32 v13, 0, v13, vcc
    v_add_f32 v12, v12, v13
    v_cmp_gt_f32 s[52:53], v10, s54
    v_cmp_lt_f32 s[56:57], v10, s55
    v_cmp_lt_f32 vcc, v12, s58
    s_and_b64 s[52:53], s[52:53], s[56:57]
    s_and_b64 s[52:53], s[52:53], vcc
    s_cmp_eq_u64 s[52:53], exec
    s_cbranch_scc0 L_at_slow
    s_branch L_at_done
L_at_slow:
    s_waitcnt vmcnt(0)
    v_and_b32 v6, 31, v2
    v_lshlrev_b32 v4, 3, v6
    v_lshrrev_b32 v7, 5, v2
    v_mul_u32_u24 v5, 320, v7
    v_lshl_add_u32 v5, v6, 4, v5
    v_cmp_gt_u32 vcc, 32, v2
    v_mov_b32 v14, 0xff800000
    s_mov_b32 s50, s42
    v_cndmask_b32 v92, 0, v92, vcc
    s_mov_b32 s45, 64
L_at_slow1:
    buffer_load_dwordx4 v[100:103], v9, s[32:35], s50 offen sc1
    buffer_load_dwordx2 v[104:105], v4, s[32:35], s50 offen offset:1024 sc1
    s_waitcnt vmcnt(0)
    v_mfma_f32_32x32x16_bf16 v[16:31], v[100:103], v[88:91], 0
    v_mfma_f32_32x32x8_bf16 v[16:31], v[104:105], v[92:93], v[16:31]
    s_nop 11
    v_max3_f32 v8, v16, v17, v18
    v_max3_f32 v10, v19, v20, v21
    v_max3_f32 v8, v8, v22, v23
    v_max3_f32 v10, v10, v24, v25
    v_max3_f32 v8, v8, v26, v27
    v_max3_f32 v10, v10, v28, v29
    v_max3_f32 v8, v8, v30, v31
    v_max_f32 v8, v8, v10
    v_mov_b32 v10, v8
    s_nop 1
    v_permlane32_swap_b32 v8, v10
    v_max_f32 v8, v8, v10
    v_max_f32 v14, v14, v8
    s_add_u32 s50, s50, 2560
    s_sub_u32 s45, s45, 1
    s_cmp_lg_u32 s45, 0
    s_cbranch_scc1 L_at_slow1
    v_sub_f32 v8, 0, v14
    v_mov_b32 v72, v8
    v_mov_b32 v56, 0
    v_mov_b32 v73, v8
    v_mov_b32 v57, 0
    v_mov_b32 v74, v8
    v_mov_b32 v58, 0
    v_mov_b32 v75, v8
    v_mov_b32 v59, 0
    v_mov_b32 v76, v8
    v_mov_b32 v60, 0
    v_mov_b32 v77, v8
    v_mov_b32 v61, 0
    v_mov_b32 v78, v8
    v_mov_b32 v62, 0
    v_mov_b32 v79, v8
    v_mov_b32 v63, 0
    v_mov_b32 v80, v8
    v_mov_b32 v64, 0
    v_mov_b32 v81, v8
    v_mov_b32 v65, 0
    v_mov_b32 v82, v8
    v_mov_b32 v66, 0
    v_mov_b32 v83, v8
    v_mov_b32 v67, 0
    v_mov_b32 v84, v8
    v_mov_b32 v68, 0
    v_mov_b32 v85, v8
    v_mov_b32 v69, 0
    v_mov_b32 v86, v8
    v_mov_b32 v70, 0
    v_mov_b32 v87, v8
    v_mov_b32 v71, 0
    s_mov_b32 s50, s42
    s_mov_b32 s45, 64
L_at_slow2:
    buffer_load_dwordx4 v[100:103], v9, s[32:35], s50 offen sc1
    buffer_load_dwordx2 v[104:105], v4, s[32:35], s50 offen offset:1024 sc1
    s_mov_b64 exec, s[30:31]
    buffer_load_dwordx4 v[112:115], v5, s[32:35], s50 offen offset:1280 sc1
    buffer_load_dwordx4 v[116:119], v5, s[32:35], s50 offen offset:1920 sc1
    s_mov_b64 exec, -1
    s_waitcnt vmcnt(0)
    v_mfma_f32_32x32x16_bf16 v[16:31], v[100:103], v[88:91], v[72:87]
    v_mfma_f32_32x32x8_bf16 v[16:31], v[104:105], v[92:93], v[16:31]
    s_nop 11
    v_exp_f32 v16, v16
    v_exp_f32 v17, v17
    v_exp_f32 v18, v18
    v_exp_f32 v19, v19
    v_exp_f32 v20, v20
    v_exp_f32 v21, v21
    v_exp_f32 v22, v22
    v_exp_f32 v23, v23
    v_exp_f32 v24, v24
    v_exp_f32 v25, v25
    v_exp_f32 v26, v26
    v_exp_f32 v27, v27
    v_exp_f32 v28, v28
    v_exp_f32 v29, v29
    v_exp_f32 v30, v30
    v_exp_f32 v31, v31
    s_nop 0
    v_cvt_pk_bf16_f32 v48, v16, v17
    v_cvt_pk_bf16_f32 v49, v18, v19
    v_cvt_pk_bf16_f32 v50, v20, v21
    v_cvt_pk_bf16_f32 v51, v22, v23
    v_cvt_pk_bf16_f32 v52, v24, v25
    v_cvt_pk_bf16_f32 v53, v26, v27
    v_cvt_pk_bf16_f32 v54, v28, v29
    v_cvt_pk_bf16_f32 v55, v30, v31
    s_nop 1
    v_mfma_f32_32x32x16_bf16 v[56:71], v[112:115], v[48:51], v[56:71]
    v_mfma_f32_32x32x16_bf16 v[56:71], v[116:119], v[52:55], v[56:71]
    s_add_u32 s50, s50, 2560
    s_sub_u32 s45, s45, 1
    s_cmp_lg_u32 s45, 0
    s_cbranch_scc1 L_at_slow2
    s_mov_b32 s51, 1
    s_nop 10
    s_branch L_at_fin
L_at_done:
    s_waitcnt vmcnt(0)
    s_barrier
    s_cmp_lg_u32 s25, 0
    s_cbranch_scc1 L_w019
    s_lshl_b32 s63, s27, 5
    s_add_u32 s63, s63, s24
    s_lshl_b32 s62, s63, 7
    s_add_u32 s62, s62, 21233664
    v_mov_b32 v0, 0
    v_mov_b32 v10, s60
    v_mov_b32 v11, s61
    s_mov_b64 exec, 1
    buffer_store_dwordx2 v[10:11], v0, s[32:35], s62 offen sc1
    s_mov_b64 exec, -1
L_w019:
    s_endpgm
L_roleB:
    s_sub_u32 s3, s2, 256
    s_and_b32 s24, s3, 7
    s_lshr_b32 s26, s3, 3
    s_lshr_b32 s27, s24, 2
    s_lshl_b32 s27, s27, 2
    s_and_b32 s3, s26, 3
    s_add_u32 s27, s27, s3
    s_and_b32 s24, s24, 3
    s_lshl_b32 s24, s24, 3
    s_lshr_b32 s26, s26, 2
    s_add_u32 s24, s24, s26
    s_lshl_b32 s26, s27, 3
    s_add_u32 s26, s26, s25
    s_sub_u32 s50, s2, 256
    s_cmp_lg_u32 s25, 1
    s_cbranch_scc1 L_warm20_0
    s_mov_b32 s36, s6
    s_mov_b32 s37, s7
    s_mov_b32 s38, 2457600
    s_mov_b32 s39, 0x00020000
    s_mul_i32 s51, s50, 4800
    buffer_load_dwordx4 v[96:99], v9, s[36:39], s51 offen offset:0
    buffer_load_dwordx4 v[100:103], v9, s[36:39], s51 offen offset:1024
    buffer_load_dwordx4 v[104:107], v9, s[36:39], s51 offen offset:2048
    buffer_load_dwordx4 v[108:111], v9, s[36:39], s51 offen offset:3072
    s_add_u32 s51, s51, 4096
    buffer_load_dwordx4 v[112:115], v9, s[36:39], s51 offen offset:0
    s_waitcnt vmcnt(0)
L_warm20_0:
    s_cmp_lg_u32 s25, 2
    s_cbranch_scc1 L_warm20_1
    s_mov_b32 s36, s6
    s_mov_b32 s37, s7
    s_mov_b32 s38, 2457600
    s_mov_b32 s39, 0x00020000
    s_mul_i32 s51, s50, 4800
    s_add_u32 s51, s51, 1228800
    buffer_load_dwordx4 v[96:99], v9, s[36:39], s51 offen offset:0
    buffer_load_dwordx4 v[100:103], v9, s[36:39], s51 offen offset:1024
    buffer_load_dwordx4 v[104:107], v9, s[36:39], s51 offen offset:2048
    buffer_load_dwordx4 v[108:111], v9, s[36:39], s51 offen offset:3072
    s_add_u32 s51, s51, 4096
    buffer_load_dwordx4 v[112:115], v9, s[36:39], s51 offen offset:0
    s_waitcnt vmcnt(0)
L_warm20_1:
    s_cmp_lg_u32 s25, 0
    s_cbranch_scc1 L_w021
    s_mov_b32 s56, s20
    s_mov_b32 s57, s21
    s_mov_b32 s58, 256
    s_mov_b32 s59, 0x00020000
L_nonce22:
    s_mov_b32 s83, 0x40000
    v_mov_b32 v12, 0
L_wn23:
    buffer_load_dwordx2 v[10:11], v12, s[56:59], 0 offen sc1
L_wn23_chk:
    s_waitcnt vmcnt(0)
    v_readfirstlane_b32 s60, v10
    v_readfirstlane_b32 s61, v11
    s_min_u32 s62, s60, s61
    s_cmp_lg_u32 s62, 0
    s_cbranch_scc1 L_wn23_ok
    s_sleep 16
    s_sub_u32 s83, s83, 1
    s_cbranch_scc0 L_wn23
L_wn23_ok:
L_w021:
    s_mul_i32 s40, s26, 40960
    s_add_u32 s40, s40, 0
    s_mul_i32 s41, s24, 96
    s_and_b32 s3, s25, 3
    s_mul_i32 s42, s3, 3072
    s_cmp_ge_u32 s25, 4
    s_cselect_b32 s43, 12416, 0
    s_cselect_b32 s28, s14, s12
    s_cselect_b32 s29, s15, s13
    s_mov_b32 s30, 1966080
    s_mov_b32 s31, 0x00020000
    s_add_u32 s42, s42, s43
    s_mul_i32 s3, s3, 192
    s_movk_i32 s43, 3072
    v_add_u32 v8, s3, v2
    v_mul_u32_u24 v10, 10923, v8
    v_lshrrev_b32 v10, 16, v10
    v_mul_u32_u24 v11, 6, v10
    v_sub_u32 v11, v8, v11
    v_lshlrev_b32 v11, 4, v11
    v_bfe_u32 v8, v10, 2, 1
    v_bfe_u32 v12, v10, 3, 1
    v_xor_b32 v8, v8, v12
    v_mul_u32_u24 v8, 12, v8
    v_xor_b32 v10, v10, v8
    v_mad_u32_u24 v4, v10, s43, v11
    v_add_u32 v8, s3, v2
    v_add_u32 v8, 64, v8
    v_mul_u32_u24 v10, 10923, v8
    v_lshrrev_b32 v10, 16, v10
    v_mul_u32_u24 v11, 6, v10
    v_sub_u32 v11, v8, v11
    v_lshlrev_b32 v11, 4, v11
    v_bfe_u32 v8, v10, 2, 1
    v_bfe_u32 v12, v10, 3, 1
    v_xor_b32 v8, v8, v12
    v_mul_u32_u24 v8, 12, v8
    v_xor_b32 v10, v10, v8
    v_mad_u32_u24 v5, v10, s43, v11
    v_add_u32 v8, s3, v2
    v_add_u32 v8, 128, v8
    v_mul_u32_u24 v10, 10923, v8
    v_lshrrev_b32 v10, 16, v10
    v_mul_u32_u24 v11, 6, v10
    v_sub_u32 v11, v8, v11
    v_lshlrev_b32 v11, 4, v11
    v_bfe_u32 v8, v10, 2, 1
    v_bfe_u32 v12, v10, 3, 1
    v_xor_b32 v8, v8, v12
    v_mul_u32_u24 v8, 12, v8
    v_xor_b32 v10, v10, v8
    v_mad_u32_u24 v6, v10, s43, v11
    v_bfe_u32 v8, v2, 2, 2
    v_lshrrev_b32 v10, 5, v2
    v_lshl_add_u32 v8, v10, 3, v8
    v_mul_u32_u24 v8, 96, v8
    v_and_b32 v10, 3, v2
    v_lshl_add_u32 v8, v10, 3, v8
    v_bfe_u32 v10, v2, 4, 1
    v_mul_u32_u24 v10, 12416, v10
    v_add_u32 v7, v8, v10
    v_add_u32 v8, 49664, v7
    v_mov_b32 v16, 0
    v_mov_b32 v17, 0
    v_mov_b32 v18, 0
    v_mov_b32 v19, 0
    v_mov_b32 v20, 0
    v_mov_b32 v21, 0
    v_mov_b32 v22, 0
    v_mov_b32 v23, 0
    v_mov_b32 v24, 0
    v_mov_b32 v25, 0
    v_mov_b32 v26, 0
    v_mov_b32 v27, 0
    v_mov_b32 v28, 0
    v_mov_b32 v29, 0
    v_mov_b32 v30, 0
    v_mov_b32 v31, 0
    v_mov_b32 v32, 0
    v_mov_b32 v33, 0
    v_mov_b32 v34, 0
    v_mov_b32 v35, 0
    v_mov_b32 v36, 0
    v_mov_b32 v37, 0
    v_mov_b32 v38, 0
    v_mov_b32 v39, 0
    v_mov_b32 v40, 0
    v_mov_b32 v41, 0
    v_mov_b32 v42, 0
    v_mov_b32 v43, 0
    v_mov_b32 v44, 0
    v_mov_b32 v45, 0
    v_mov_b32 v46, 0
    v_mov_b32 v47, 0
    v_mov_b32 v48, 0
    v_mov_b32 v49, 0
    v_mov_b32 v50, 0
    v_mov_b32 v51, 0
    v_mov_b32 v52, 0
    v_mov_b32 v53, 0
    v_mov_b32 v54, 0
    v_mov_b32 v55, 0
    v_mov_b32 v56, 0
    v_mov_b32 v57, 0
    v_mov_b32 v58, 0
    v_mov_b32 v59, 0
    v_mov_b32 v60, 0
    v_mov_b32 v61, 0
    v_mov_b32 v62, 0
    v_mov_b32 v63, 0
    v_lshrrev_b32 v10, 4, v2
    v_and_b32 v11, 15, v2
    v_lshlrev_b32 v3, 4, v11
    v_lshl_add_u32 v3, v10, 9, v3
    v_and_b32 v12, 1, v10
    v_lshlrev_b32 v14, 4, v11
    v_lshl_add_u32 v14, v12, 9, v14
    v_lshrrev_b32 v13, 5, v2
    v_lshl_add_u32 v14, v13, 8, v14
    v_bfe_u32 v8, v2, 2, 2
    v_lshl_add_u32 v8, v13, 4, v8
    v_lshl_add_u32 v7, v12, 2, v8
    v_add_u32 v8, 8, v7
    v_and_b32 v10, 3, v2
    v_lshlrev_b32 v10, 3, v10
    s_movk_i32 s3, 96
    v_mad_u32_u24 v7, v7, s3, v10
    v_mad_u32_u24 v8, v8, s3, v10
    v_add_u32 v12, 49664, v7
    v_add_u32 v13, 49664, v8
    s_cmp_lg_u32 s25, 0
    s_cbranch_scc1 L_w024
    s_lshl_b32 s63, s27, 6
    v_and_b32 v0, 63, v2
    v_add_u32 v0, s63, v0
    v_lshlrev_b32 v0, 7, v0
    v_add_u32 v0, 20971520, v0
    s_mov_b32 s83, 0x40000
    s_mov_b64 exec, 1
L_poll25:
    buffer_load_dwordx2 v[10:11], v0, s[32:35], 0 offen sc1
    s_waitcnt vmcnt(0)
    v_cmp_ne_u64 vcc, s[60:61], v[10:11]
    s_cbranch_vccz L_poll25_1
    s_sleep 8
    s_sub_u32 s83, s83, 1
    s_cbranch_scc0 L_poll25
L_poll25_1:
    s_mov_b64 exec, -2
L_poll25_2:
    buffer_load_dwordx2 v[10:11], v0, s[32:35], 0 offen sc1
    s_waitcnt vmcnt(0)
    v_cmp_ne_u64 vcc, s[60:61], v[10:11]
    s_cbranch_vccz L_poll25_ok
    s_mov_b64 exec, vcc
    s_sleep 1
    s_sub_u32 s83, s83, 1
    s_cbranch_scc0 L_poll25_2
L_poll25_ok:
    s_mov_b64 exec, -1
    s_cmp_ge_u32 s2, 496
    s_cbranch_scc1 L_b_noql
    s_sub_u32 s63, s2, 256
    s_lshl_b32 s63, s63, 7
    s_add_u32 s63, s63, 21102592
    s_mov_b32 s83, 0x40000
L_b_sq:
    s_load_dwordx2 s[88:89], s[22:23], s63 glc
    s_waitcnt lgkmcnt(0)
    s_cmp_eq_u64 s[88:89], s[60:61]
    s_cbranch_scc1 L_b_noql
    s_sleep 4
    s_sub_u32 s83, s83, 1
    s_cbranch_scc0 L_b_sq
L_b_noql:
L_w024:
    s_barrier
    s_setprio 0
    s_add_u32 m0, s42, 0
    s_nop 0
    buffer_load_dwordx4 v4, s[28:31], s41 offen lds
    s_add_u32 m0, s42, 1024
    s_nop 0
    buffer_load_dwordx4 v5, s[28:31], s41 offen lds
    s_add_u32 m0, s42, 2048
    s_nop 0
    buffer_load_dwordx4 v6, s[28:31], s41 offen lds
    s_add_u32 s41, s41, 393216
    buffer_load_dwordx4 v[64:67], v3, s[32:35], s40 offen offset:0 sc1
    buffer_load_dwordx4 v[68:71], v3, s[32:35], s40 offen offset:256 sc1
    buffer_load_dwordx4 v[72:75], v3, s[32:35], s40 offen offset:2048 sc1
    buffer_load_dwordx4 v[76:79], v3, s[32:35], s40 offen offset:2304 sc1
    s_add_u32 s40, s40, 4096
    s_barrier
    buffer_load_dwordx4 v[80:83], v3, s[32:35], s40 offen offset:0 sc1
    buffer_load_dwordx4 v[84:87], v3, s[32:35], s40 offen offset:256 sc1
    buffer_load_dwordx4 v[88:91], v3, s[32:35], s40 offen offset:2048 sc1
    buffer_load_dwordx4 v[92:95], v3, s[32:35], s40 offen offset:2304 sc1
    s_add_u32 s40, s40, 4096
    s_waitcnt vmcnt(8)
    s_barrier
    ds_read_b64_tr_b16 v[96:97], v7 offset:0
    ds_read_b64_tr_b16 v[98:99], v8 offset:0
    ds_read_b64_tr_b16 v[100:101], v7 offset:32
    ds_read_b64_tr_b16 v[102:103], v8 offset:32
    ds_read_b64_tr_b16 v[104:105], v7 offset:64
    ds_read_b64_tr_b16 v[106:107], v8 offset:64
    ds_read_b64_tr_b16 v[108:109], v7 offset:12416
    ds_read_b64_tr_b16 v[110:111], v8 offset:12416
    ds_read_b64_tr_b16 v[112:113], v7 offset:12448
    ds_read_b64_tr_b16 v[114:115], v8 offset:12448
    ds_read_b64_tr_b16 v[116:117], v7 offset:12480
    ds_read_b64_tr_b16 v[118:119], v8 offset:12480
    s_waitcnt vmcnt(6) lgkmcnt(6)
    v_mfma_f32_16x16x32_bf16 v[16:19], v[96:99], v[64:67], v[16:19]
    v_mfma_f32_16x16x32_bf16 v[20:23], v[96:99], v[68:71], v[20:23]
    v_mfma_f32_16x16x32_bf16 v[32:35], v[100:103], v[64:67], v[32:35]
    v_mfma_f32_16x16x32_bf16 v[36:39], v[100:103], v[68:71], v[36:39]
    v_mfma_f32_16x16x32_bf16 v[48:51], v[104:107], v[64:67], v[48:51]
    v_mfma_f32_16x16x32_bf16 v[52:55], v[104:107], v[68:71], v[52:55]
    ds_read_b64_tr_b16 v[96:97], v7 offset:3072
    ds_read_b64_tr_b16 v[98:99], v8 offset:3072
    ds_read_b64_tr_b16 v[100:101], v7 offset:3104
    ds_read_b64_tr_b16 v[102:103], v8 offset:3104
    ds_read_b64_tr_b16 v[104:105], v7 offset:3136
    ds_read_b64_tr_b16 v[106:107], v8 offset:3136
    s_waitcnt lgkmcnt(6)
    v_mfma_f32_16x16x32_bf16 v[24:27], v[108:111], v[64:67], v[24:27]
    v_mfma_f32_16x16x32_bf16 v[28:31], v[108:111], v[68:71], v[28:31]
    v_mfma_f32_16x16x32_bf16 v[40:43], v[112:115], v[64:67], v[40:43]
    v_mfma_f32_16x16x32_bf16 v[44:47], v[112:115], v[68:71], v[44:47]
    v_mfma_f32_16x16x32_bf16 v[56:59], v[116:119], v[64:67], v[56:59]
    v_mfma_f32_16x16x32_bf16 v[60:63], v[116:119], v[68:71], v[60:63]
    ds_read_b64_tr_b16 v[108:109], v7 offset:15488
    ds_read_b64_tr_b16 v[110:111], v8 offset:15488
    ds_read_b64_tr_b16 v[112:113], v7 offset:15520
    ds_read_b64_tr_b16 v[114:115], v8 offset:15520
    ds_read_b64_tr_b16 v[116:117], v7 offset:15552
    ds_read_b64_tr_b16 v[118:119], v8 offset:15552
    s_waitcnt vmcnt(4) lgkmcnt(6)
    v_mfma_f32_16x16x32_bf16 v[16:19], v[96:99], v[72:75], v[16:19]
    v_mfma_f32_16x16x32_bf16 v[20:23], v[96:99], v[76:79], v[20:23]
    v_mfma_f32_16x16x32_bf16 v[32:35], v[100:103], v[72:75], v[32:35]
    v_mfma_f32_16x16x32_bf16 v[36:39], v[100:103], v[76:79], v[36:39]
    v_mfma_f32_16x16x32_bf16 v[48:51], v[104:107], v[72:75], v[48:51]
    v_mfma_f32_16x16x32_bf16 v[52:55], v[104:107], v[76:79], v[52:55]
    ds_read_b64_tr_b16 v[96:97], v7 offset:6144
    ds_read_b64_tr_b16 v[98:99], v8 offset:6144
    ds_read_b64_tr_b16 v[100:101], v7 offset:6176
    ds_read_b64_tr_b16 v[102:103], v8 offset:6176
    ds_read_b64_tr_b16 v[104:105], v7 offset:6208
    ds_read_b64_tr_b16 v[106:107], v8 offset:6208
    s_waitcnt lgkmcnt(6)
    v_mfma_f32_16x16x32_bf16 v[24:27], v[108:111], v[72:75], v[24:27]
    v_mfma_f32_16x16x32_bf16 v[28:31], v[108:111], v[76:79], v[28:31]
    v_mfma_f32_16x16x32_bf16 v[40:43], v[112:115], v[72:75], v[40:43]
    v_mfma_f32_16x16x32_bf16 v[44:47], v[112:115], v[76:79], v[44:47]
    v_mfma_f32_16x16x32_bf16 v[56:59], v[116:119], v[72:75], v[56:59]
    v_mfma_f32_16x16x32_bf16 v[60:63], v[116:119], v[76:79], v[60:63]
    ds_read_b64_tr_b16 v[108:109], v7 offset:18560
    ds_read_b64_tr_b16 v[110:111], v8 offset:18560
    ds_read_b64_tr_b16 v[112:113], v7 offset:18592
    ds_read_b64_tr_b16 v[114:115], v8 offset:18592
    ds_read_b64_tr_b16 v[116:117], v7 offset:18624
    ds_read_b64_tr_b16 v[118:119], v8 offset:18624
    s_waitcnt vmcnt(2) lgkmcnt(6)
    v_mfma_f32_16x16x32_bf16 v[16:19], v[96:99], v[80:83], v[16:19]
    v_mfma_f32_16x16x32_bf16 v[20:23], v[96:99], v[84:87], v[20:23]
    v_mfma_f32_16x16x32_bf16 v[32:35], v[100:103], v[80:83], v[32:35]
    v_mfma_f32_16x16x32_bf16 v[36:39], v[100:103], v[84:87], v[36:39]
    v_mfma_f32_16x16x32_bf16 v[48:51], v[104:107], v[80:83], v[48:51]
    v_mfma_f32_16x16x32_bf16 v[52:55], v[104:107], v[84:87], v[52:55]
    ds_read_b64_tr_b16 v[96:97], v7 offset:9216
    ds_read_b64_tr_b16 v[98:99], v8 offset:9216
    ds_read_b64_tr_b16 v[100:101], v7 offset:9248
    ds_read_b64_tr_b16 v[102:103], v8 offset:9248
    ds_read_b64_tr_b16 v[104:105], v7 offset:9280
    ds_read_b64_tr_b16 v[106:107], v8 offset:9280
    s_waitcnt lgkmcnt(6)
    v_mfma_f32_16x16x32_bf16 v[24:27], v[108:111], v[80:83], v[24:27]
    v_mfma_f32_16x16x32_bf16 v[28:31], v[108:111], v[84:87], v[28:31]
    v_mfma_f32_16x16x32_bf16 v[40:43], v[112:115], v[80:83], v[40:43]
    v_mfma_f32_16x16x32_bf16 v[44:47], v[112:115], v[84:87], v[44:47]
    v_mfma_f32_16x16x32_bf16 v[56:59], v[116:119], v[80:83], v[56:59]
    v_mfma_f32_16x16x32_bf16 v[60:63], v[116:119], v[84:87], v[60:63]
    ds_read_b64_tr_b16 v[108:109], v7 offset:21632
    ds_read_b64_tr_b16 v[110:111], v8 offset:21632
    ds_read_b64_tr_b16 v[112:113], v7 offset:21664
    ds_read_b64_tr_b16 v[114:115], v8 offset:21664
    ds_read_b64_tr_b16 v[116:117], v7 offset:21696
    ds_read_b64_tr_b16 v[118:119], v8 offset:21696
    s_waitcnt vmcnt(0) lgkmcnt(6)
    v_mfma_f32_16x16x32_bf16 v[16:19], v[96:99], v[88:91], v[16:19]
    v_mfma_f32_16x16x32_bf16 v[20:23], v[96:99], v[92:95], v[20:23]
    v_mfma_f32_16x16x32_bf16 v[32:35], v[100:103], v[88:91], v[32:35]
    v_mfma_f32_16x16x32_bf16 v[36:39], v[100:103], v[92:95], v[36:39]
    v_mfma_f32_16x16x32_bf16 v[48:51], v[104:107], v[88:91], v[48:51]
    v_mfma_f32_16x16x32_bf16 v[52:55], v[104:107], v[92:95], v[52:55]
    s_cmp_lg_u32 s25, 0
    s_cbranch_scc1 L_w026
    s_sub_u32 s63, s2, 256
    s_lshl_b32 s63, s63, 7
    s_add_u32 s63, s63, 21364736
    s_mov_b32 s83, 0x40000
L_b_s2:
    s_load_dwordx2 s[88:89], s[22:23], s63 glc
    s_waitcnt lgkmcnt(0)
    s_cmp_eq_u64 s[88:89], s[60:61]
    s_cbranch_scc1 L_b_s2ok
    s_sleep 2
    s_sub_u32 s83, s83, 1
    s_cbranch_scc0 L_b_s2
L_b_s2ok:
L_w026:
    s_barrier
    s_add_u32 m0, s42, 24832
    s_nop 0
    buffer_load_dwordx4 v4, s[28:31], s41 offen lds
    s_add_u32 m0, s42, 25856
    s_nop 0
    buffer_load_dwordx4 v5, s[28:31], s41 offen lds
    s_add_u32 m0, s42, 26880
    s_nop 0
    buffer_load_dwordx4 v6, s[28:31], s41 offen lds
    s_add_u32 s41, s41, 393216
    buffer_load_dwordx4 v[64:67], v3, s[32:35], s40 offen offset:0 sc1
    buffer_load_dwordx4 v[68:71], v3, s[32:35], s40 offen offset:256 sc1
    buffer_load_dwordx4 v[72:75], v3, s[32:35], s40 offen offset:2048 sc1
    buffer_load_dwordx4 v[76:79], v3, s[32:35], s40 offen offset:2304 sc1
    s_add_u32 s40, s40, 4096
    buffer_load_dwordx4 v[80:83], v3, s[32:35], s40 offen offset:0 sc1
    buffer_load_dwordx4 v[84:87], v3, s[32:35], s40 offen offset:256 sc1
    s_add_u32 m0, s42, 49664
    s_nop 0
    buffer_load_dwordx4 v4, s[28:31], s41 offen lds
    s_add_u32 m0, s42, 50688
    s_nop 0
    buffer_load_dwordx4 v5, s[28:31], s41 offen lds
    s_add_u32 m0, s42, 51712
    s_nop 0
    buffer_load_dwordx4 v6, s[28:31], s41 offen lds
    s_add_u32 s41, s41, 393216
    s_waitcnt vmcnt(9) lgkmcnt(0)
    s_barrier
    s_add_u32 m0, s42, 0
    s_nop 0
    buffer_load_dwordx4 v4, s[28:31], s41 offen lds
    s_add_u32 m0, s42, 1024
    s_nop 0
    buffer_load_dwordx4 v5, s[28:31], s41 offen lds
    s_add_u32 m0, s42, 2048
    s_nop 0
    buffer_load_dwordx4 v6, s[28:31], s41 offen lds
    s_add_u32 s41, s41, 393216
    ds_read_b64_tr_b16 v[96:97], v7 offset:24832
    ds_read_b64_tr_b16 v[98:99], v8 offset:24832
    ds_read_b64_tr_b16 v[100:101], v7 offset:24864
    ds_read_b64_tr_b16 v[102:103], v8 offset:24864
    ds_read_b64_tr_b16 v[104:105], v7 offset:24896
    ds_read_b64_tr_b16 v[106:107], v8 offset:24896
    s_waitcnt lgkmcnt(6)
    v_mfma_f32_16x16x32_bf16 v[24:27], v[108:111], v[88:91], v[24:27]
    v_mfma_f32_16x16x32_bf16 v[28:31], v[108:111], v[92:95], v[28:31]
    v_mfma_f32_16x16x32_bf16 v[40:43], v[112:115], v[88:91], v[40:43]
    v_mfma_f32_16x16x32_bf16 v[44:47], v[112:115], v[92:95], v[44:47]
    v_mfma_f32_16x16x32_bf16 v[56:59], v[116:119], v[88:91], v[56:59]
    v_mfma_f32_16x16x32_bf16 v[60:63], v[116:119], v[92:95], v[60:63]
    buffer_load_dwordx4 v[88:91], v3, s[32:35], s40 offen offset:2048 sc1
    buffer_load_dwordx4 v[92:95], v3, s[32:35], s40 offen offset:2304 sc1
    s_add_u32 s40, s40, 4096
    ds_read_b64_tr_b16 v[108:109], v7 offset:37248
    ds_read_b64_tr_b16 v[110:111], v8 offset:37248
    ds_read_b64_tr_b16 v[112:113], v7 offset:37280
    ds_read_b64_tr_b16 v[114:115], v8 offset:37280
    ds_read_b64_tr_b16 v[116:117], v7 offset:37312
    ds_read_b64_tr_b16 v[118:119], v8 offset:37312
    s_waitcnt vmcnt(12) lgkmcnt(6)
    v_mfma_f32_16x16x32_bf16 v[16:19], v[96:99], v[64:67], v[16:19]
    v_mfma_f32_16x16x32_bf16 v[20:23], v[96:99], v[68:71], v[20:23]
    v_mfma_f32_16x16x32_bf16 v[32:35], v[100:103], v[64:67], v[32:35]
    v_mfma_f32_16x16x32_bf16 v[36:39], v[100:103], v[68:71], v[36:39]
    v_mfma_f32_16x16x32_bf16 v[48:51], v[104:107], v[64:67], v[48:51]
    v_mfma_f32_16x16x32_bf16 v[52:55], v[104:107], v[68:71], v[52:55]
    ds_read_b64_tr_b16 v[96:97], v7 offset:27904
    ds_read_b64_tr_b16 v[98:99], v8 offset:27904
    ds_read_b64_tr_b16 v[100:101], v7 offset:27936
    ds_read_b64_tr_b16 v[102:103], v8 offset:27936
    ds_read_b64_tr_b16 v[104:105], v7 offset:27968
    ds_read_b64_tr_b16 v[106:107], v8 offset:27968
    s_waitcnt lgkmcnt(6)
    v_mfma_f32_16x16x32_bf16 v[24:27], v[108:111], v[64:67], v[24:27]
    v_mfma_f32_16x16x32_bf16 v[28:31], v[108:111], v[68:71], v[28:31]
    v_mfma_f32_16x16x32_bf16 v[40:43], v[112:115], v[64:67], v[40:43]
    v_mfma_f32_16x16x32_bf16 v[44:47], v[112:115], v[68:71], v[44:47]
    v_mfma_f32_16x16x32_bf16 v[56:59], v[116:119], v[64:67], v[56:59]
    v_mfma_f32_16x16x32_bf16 v[60:63], v[116:119], v[68:71], v[60:63]
    buffer_load_dwordx4 v[64:67], v3, s[32:35], s40 offen offset:0 sc1
    buffer_load_dwordx4 v[68:71], v3, s[32:35], s40 offen offset:256 sc1
    ds_read_b64_tr_b16 v[108:109], v7 offset:40320
    ds_read_b64_tr_b16 v[110:111], v8 offset:40320
    ds_read_b64_tr_b16 v[112:113], v7 offset:40352
    ds_read_b64_tr_b16 v[114:115], v8 offset:40352
    ds_read_b64_tr_b16 v[116:117], v7 offset:40384
    ds_read_b64_tr_b16 v[118:119], v8 offset:40384
    s_waitcnt vmcnt(12) lgkmcnt(6)
    v_mfma_f32_16x16x32_bf16 v[16:19], v[96:99], v[72:75], v[16:19]
    v_mfma_f32_16x16x32_bf16 v[20:23], v[96:99], v[76:79], v[20:23]
    v_mfma_f32_16x16x32_bf16 v[32:35], v[100:103], v[72:75], v[32:35]
    v_mfma_f32_16x16x32_bf16 v[36:39], v[100:103], v[76:79], v[36:39]
    v_mfma_f32_16x16x32_bf16 v[48:51], v[104:107], v[72:75], v[48:51]
    v_mfma_f32_16x16x32_bf16 v[52:55], v[104:107], v[76:79], v[52:55]
    ds_read_b64_tr_b16 v[96:97], v7 offset:30976
    ds_read_b64_tr_b16 v[98:99], v8 offset:30976
    ds_read_b64_tr_b16 v[100:101], v7 offset:31008
    ds_read_b64_tr_b16 v[102:103], v8 offset:31008
    ds_read_b64_tr_b16 v[104:105], v7 offset:31040
    ds_read_b64_tr_b16 v[106:107], v8 offset:31040
    s_waitcnt lgkmcnt(6)
    v_mfma_f32_16x16x32_bf16 v[24:27], v[108:111], v[72:75], v[24:27]
    v_mfma_f32_16x16x32_bf16 v[28:31], v[108:111], v[76:79], v[28:31]
    v_mfma_f32_16x16x32_bf16 v[40:43], v[112:115], v[72:75], v[40:43]
    v_mfma_f32_16x16x32_bf16 v[44:47], v[112:115], v[76:79], v[44:47]
    v_mfma_f32_16x16x32_bf16 v[56:59], v[116:119], v[72:75], v[56:59]
    v_mfma_f32_16x16x32_bf16 v[60:63], v[116:119], v[76:79], v[60:63]
    buffer_load_dwordx4 v[72:75], v3, s[32:35], s40 offen offset:2048 sc1
    buffer_load_dwordx4 v[76:79], v3, s[32:35], s40 offen offset:2304 sc1
    s_add_u32 s40, s40, 4096
    ds_read_b64_tr_b16 v[108:109], v7 offset:43392
    ds_read_b64_tr_b16 v[110:111], v8 offset:43392
    ds_read_b64_tr_b16 v[112:113], v7 offset:43424
    ds_read_b64_tr_b16 v[114:115], v8 offset:43424
    ds_read_b64_tr_b16 v[116:117], v7 offset:43456
    ds_read_b64_tr_b16 v[118:119], v8 offset:43456
    s_waitcnt vmcnt(12) lgkmcnt(6)
    v_mfma_f32_16x16x32_bf16 v[16:19], v[96:99], v[80:83], v[16:19]
    v_mfma_f32_16x16x32_bf16 v[20:23], v[96:99], v[84:87], v[20:23]
    v_mfma_f32_16x16x32_bf16 v[32:35], v[100:103], v[80:83], v[32:35]
    v_mfma_f32_16x16x32_bf16 v[36:39], v[100:103], v[84:87], v[36:39]
    v_mfma_f32_16x16x32_bf16 v[48:51], v[104:107], v[80:83], v[48:51]
    v_mfma_f32_16x16x32_bf16 v[52:55], v[104:107], v[84:87], v[52:55]
    s_mov_b32 s36, s16
    s_mov_b32 s37, s17
    s_mov_b32 s38, 1966080
    s_mov_b32 s39, 0x00020000
    s_mov_b32 s52, s8
    s_mov_b32 s53, s9
    s_mov_b32 s54, 819200
    s_mov_b32 s55, 0x00020000
    s_sub_u32 s50, s2, 256
    s_lshl_b32 s50, s50, 3
    s_add_u32 s50, s50, s25
    s_mul_i32 s51, s50, 960
    s_mul_i32 s50, s50, 400
    buffer_load_dwordx4 v[120:123], v9, s[36:39], s51 offen
    buffer_load_dwordx4 v[124:127], v9, s[52:55], s50 offen
    ds_read_b64_tr_b16 v[96:97], v7 offset:34048
    ds_read_b64_tr_b16 v[98:99], v8 offset:34048
    ds_read_b64_tr_b16 v[100:101], v7 offset:34080
    ds_read_b64_tr_b16 v[102:103], v8 offset:34080
    ds_read_b64_tr_b16 v[104:105], v7 offset:34112
    ds_read_b64_tr_b16 v[106:107], v8 offset:34112
    s_waitcnt lgkmcnt(6)
    v_mfma_f32_16x16x32_bf16 v[24:27], v[108:111], v[80:83], v[24:27]
    v_mfma_f32_16x16x32_bf16 v[28:31], v[108:111], v[84:87], v[28:31]
    v_mfma_f32_16x16x32_bf16 v[40:43], v[112:115], v[80:83], v[40:43]
    v_mfma_f32_16x16x32_bf16 v[44:47], v[112:115], v[84:87], v[44:47]
    v_mfma_f32_16x16x32_bf16 v[56:59], v[116:119], v[80:83], v[56:59]
    v_mfma_f32_16x16x32_bf16 v[60:63], v[116:119], v[84:87], v[60:63]
    buffer_load_dwordx4 v[80:83], v3, s[32:35], s40 offen offset:0 sc1
    buffer_load_dwordx4 v[84:87], v3, s[32:35], s40 offen offset:256 sc1
    ds_read_b64_tr_b16 v[108:109], v7 offset:46464
    ds_read_b64_tr_b16 v[110:111], v8 offset:46464
    ds_read_b64_tr_b16 v[112:113], v7 offset:46496
    ds_read_b64_tr_b16 v[114:115], v8 offset:46496
    ds_read_b64_tr_b16 v[116:117], v7 offset:46528
    ds_read_b64_tr_b16 v[118:119], v8 offset:46528
    s_waitcnt vmcnt(8) lgkmcnt(6)
    v_mfma_f32_16x16x32_bf16 v[16:19], v[96:99], v[88:91], v[16:19]
    v_mfma_f32_16x16x32_bf16 v[20:23], v[96:99], v[92:95], v[20:23]
    v_mfma_f32_16x16x32_bf16 v[32:35], v[100:103], v[88:91], v[32:35]
    v_mfma_f32_16x16x32_bf16 v[36:39], v[100:103], v[92:95], v[36:39]
    v_mfma_f32_16x16x32_bf16 v[48:51], v[104:107], v[88:91], v[48:51]
    v_mfma_f32_16x16x32_bf16 v[52:55], v[104:107], v[92:95], v[52:55]
    s_waitcnt lgkmcnt(0)
    s_barrier
    s_add_u32 m0, s42, 24832
    s_nop 0
    buffer_load_dwordx4 v4, s[28:31], s41 offen lds
    s_add_u32 m0, s42, 25856
    s_nop 0
    buffer_load_dwordx4 v5, s[28:31], s41 offen lds
    s_add_u32 m0, s42, 26880
    s_nop 0
    buffer_load_dwordx4 v6, s[28:31], s41 offen lds
    s_add_u32 s41, s41, 393216
    ds_read_b64_tr_b16 v[96:97], v12 offset:0
    ds_read_b64_tr_b16 v[98:99], v13 offset:0
    ds_read_b64_tr_b16 v[100:101], v12 offset:32
    ds_read_b64_tr_b16 v[102:103], v13 offset:32
    ds_read_b64_tr_b16 v[104:105], v12 offset:64
    ds_read_b64_tr_b16 v[106:107], v13 offset:64
    s_waitcnt lgkmcnt(6)
    v_mfma_f32_16x16x32_bf16 v[24:27], v[108:111], v[88:91], v[24:27]
    v_mfma_f32_16x16x32_bf16 v[28:31], v[108:111], v[92:95], v[28:31]
    v_mfma_f32_16x16x32_bf16 v[40:43], v[112:115], v[88:91], v[40:43]
    v_mfma_f32_16x16x32_bf16 v[44:47], v[112:115], v[92:95], v[44:47]
    v_mfma_f32_16x16x32_bf16 v[56:59], v[116:119], v[88:91], v[56:59]
    v_mfma_f32_16x16x32_bf16 v[60:63], v[116:119], v[92:95], v[60:63]
    buffer_load_dwordx4 v[88:91], v3, s[32:35], s40 offen offset:2048 sc1
    buffer_load_dwordx4 v[92:95], v3, s[32:35], s40 offen offset:2304 sc1
    s_add_u32 s40, s40, 4096
    ds_read_b64_tr_b16 v[108:109], v12 offset:12416
    ds_read_b64_tr_b16 v[110:111], v13 offset:12416
    ds_read_b64_tr_b16 v[112:113], v12 offset:12448
    ds_read_b64_tr_b16 v[114:115], v13 offset:12448
    ds_read_b64_tr_b16 v[116:117], v12 offset:12480
    ds_read_b64_tr_b16 v[118:119], v13 offset:12480
    s_waitcnt vmcnt(11) lgkmcnt(6)
    v_mfma_f32_16x16x32_bf16 v[16:19], v[96:99], v[64:67], v[16:19]
    v_mfma_f32_16x16x32_bf16 v[20:23], v[96:99], v[68:71], v[20:23]
    v_mfma_f32_16x16x32_bf16 v[32:35], v[100:103], v[64:67], v[32:35]
    v_mfma_f32_16x16x32_bf16 v[36:39], v[100:103], v[68:71], v[36:39]
    v_mfma_f32_16x16x32_bf16 v[48:51], v[104:107], v[64:67], v[48:51]
    v_mfma_f32_16x16x32_bf16 v[52:55], v[104:107], v[68:71], v[52:55]
    ds_read_b64_tr_b16 v[96:97], v12 offset:3072
    ds_read_b64_tr_b16 v[98:99], v13 offset:3072
    ds_read_b64_tr_b16 v[100:101], v12 offset:3104
    ds_read_b64_tr_b16 v[102:103], v13 offset:3104
    ds_read_b64_tr_b16 v[104:105], v12 offset:3136
    ds_read_b64_tr_b16 v[106:107], v13 offset:3136
    s_waitcnt lgkmcnt(6)
    v_mfma_f32_16x16x32_bf16 v[24:27], v[108:111], v[64:67], v[24:27]
    v_mfma_f32_16x16x32_bf16 v[28:31], v[108:111], v[68:71], v[28:31]
    v_mfma_f32_16x16x32_bf16 v[40:43], v[112:115], v[64:67], v[40:43]
    v_mfma_f32_16x16x32_bf16 v[44:47], v[112:115], v[68:71], v[44:47]
    v_mfma_f32_16x16x32_bf16 v[56:59], v[116:119], v[64:67], v[56:59]
    v_mfma_f32_16x16x32_bf16 v[60:63], v[116:119], v[68:71], v[60:63]
    buffer_load_dwordx4 v[64:67], v3, s[32:35], s40 offen offset:0 sc1
    buffer_load_dwordx4 v[68:71], v3, s[32:35], s40 offen offset:256 sc1
    ds_read_b64_tr_b16 v[108:109], v12 offset:15488
    ds_read_b64_tr_b16 v[110:111], v13 offset:15488
    ds_read_b64_tr_b16 v[112:113], v12 offset:15520
    ds_read_b64_tr_b16 v[114:115], v13 offset:15520
    ds_read_b64_tr_b16 v[116:117], v12 offset:15552
    ds_read_b64_tr_b16 v[118:119], v13 offset:15552
    s_waitcnt vmcnt(11) lgkmcnt(6)
    v_mfma_f32_16x16x32_bf16 v[16:19], v[96:99], v[72:75], v[16:19]
    v_mfma_f32_16x16x32_bf16 v[20:23], v[96:99], v[76:79], v[20:23]
    v_mfma_f32_16x16x32_bf16 v[32:35], v[100:103], v[72:75], v[32:35]
    v_mfma_f32_16x16x32_bf16 v[36:39], v[100:103], v[76:79], v[36:39]
    v_mfma_f32_16x16x32_bf16 v[48:51], v[104:107], v[72:75], v[48:51]
    v_mfma_f32_16x16x32_bf16 v[52:55], v[104:107], v[76:79], v[52:55]
    ds_read_b64_tr_b16 v[96:97], v12 offset:6144
    ds_read_b64_tr_b16 v[98:99], v13 offset:6144
    ds_read_b64_tr_b16 v[100:101], v12 offset:6176
    ds_read_b64_tr_b16 v[102:103], v13 offset:6176
    ds_read_b64_tr_b16 v[104:105], v12 offset:6208
    ds_read_b64_tr_b16 v[106:107], v13 offset:6208
    s_waitcnt lgkmcnt(6)
    v_mfma_f32_16x16x32_bf16 v[24:27], v[108:111], v[72:75], v[24:27]
    v_mfma_f32_16x16x32_bf16 v[28:31], v[108:111], v[76:79], v[28:31]
    v_mfma_f32_16x16x32_bf16 v[40:43], v[112:115], v[72:75], v[40:43]
    v_mfma_f32_16x16x32_bf16 v[44:47], v[112:115], v[76:79], v[44:47]
    v_mfma_f32_16x16x32_bf16 v[56:59], v[116:119], v[72:75], v[56:59]
    v_mfma_f32_16x16x32_bf16 v[60:63], v[116:119], v[76:79], v[60:63]
    buffer_load_dwordx4 v[72:75], v3, s[32:35], s40 offen offset:2048 sc1
    buffer_load_dwordx4 v[76:79], v3, s[32:35], s40 offen offset:2304 sc1
    s_add_u32 s40, s40, 4096
    ds_read_b64_tr_b16 v[108:109], v12 offset:18560
    ds_read_b64_tr_b16 v[110:111], v13 offset:18560
    ds_read_b64_tr_b16 v[112:113], v12 offset:18592
    ds_read_b64_tr_b16 v[114:115], v13 offset:18592
    ds_read_b64_tr_b16 v[116:117], v12 offset:18624
    ds_read_b64_tr_b16 v[118:119], v13 offset:18624
    s_waitcnt vmcnt(9) lgkmcnt(6)
    v_mfma_f32_16x16x32_bf16 v[16:19], v[96:99], v[80:83], v[16:19]
    v_mfma_f32_16x16x32_bf16 v[20:23], v[96:99], v[84:87], v[20:23]
    v_mfma_f32_16x16x32_bf16 v[32:35], v[100:103], v[80:83], v[32:35]
    v_mfma_f32_16x16x32_bf16 v[36:39], v[100:103], v[84:87], v[36:39]
    v_mfma_f32_16x16x32_bf16 v[48:51], v[104:107], v[80:83], v[48:51]
    v_mfma_f32_16x16x32_bf16 v[52:55], v[104:107], v[84:87], v[52:55]
    ds_read_b64_tr_b16 v[96:97], v12 offset:9216
    ds_read_b64_tr_b16 v[98:99], v13 offset:9216
    ds_read_b64_tr_b16 v[100:101], v12 offset:9248
    ds_read_b64_tr_b16 v[102:103], v13 offset:9248
    ds_read_b64_tr_b16 v[104:105], v12 offset:9280
    ds_read_b64_tr_b16 v[106:107], v13 offset:9280
    s_waitcnt lgkmcnt(6)
    v_mfma_f32_16x16x32_bf16 v[24:27], v[108:111], v[80:83], v[24:27]
    v_mfma_f32_16x16x32_bf16 v[28:31], v[108:111], v[84:87], v[28:31]
    v_mfma_f32_16x16x32_bf16 v[40:43], v[112:115], v[80:83], v[40:43]
    v_mfma_f32_16x16x32_bf16 v[44:47], v[112:115], v[84:87], v[44:47]
    v_mfma_f32_16x16x32_bf16 v[56:59], v[116:119], v[80:83], v[56:59]
    v_mfma_f32_16x16x32_bf16 v[60:63], v[116:119], v[84:87], v[60:63]
    buffer_load_dwordx4 v[80:83], v3, s[32:35], s40 offen offset:0 sc1
    buffer_load_dwordx4 v[84:87], v3, s[32:35], s40 offen offset:256 sc1
    ds_read_b64_tr_b16 v[108:109], v12 offset:21632
    ds_read_b64_tr_b16 v[110:111], v13 offset:21632
    ds_read_b64_tr_b16 v[112:113], v12 offset:21664
    ds_read_b64_tr_b16 v[114:115], v13 offset:21664
    ds_read_b64_tr_b16 v[116:117], v12 offset:21696
    ds_read_b64_tr_b16 v[118:119], v13 offset:21696
    s_waitcnt vmcnt(6) lgkmcnt(6)
    v_mfma_f32_16x16x32_bf16 v[16:19], v[96:99], v[88:91], v[16:19]
    v_mfma_f32_16x16x32_bf16 v[20:23], v[96:99], v[92:95], v[20:23]
    v_mfma_f32_16x16x32_bf16 v[32:35], v[100:103], v[88:91], v[32:35]
    v_mfma_f32_16x16x32_bf16 v[36:39], v[100:103], v[92:95], v[36:39]
    v_mfma_f32_16x16x32_bf16 v[48:51], v[104:107], v[88:91], v[48:51]
    v_mfma_f32_16x16x32_bf16 v[52:55], v[104:107], v[92:95], v[52:55]
    s_waitcnt lgkmcnt(0)
    s_barrier
    ds_read_b64_tr_b16 v[96:97], v7 offset:0
    ds_read_b64_tr_b16 v[98:99], v8 offset:0
    ds_read_b64_tr_b16 v[100:101], v7 offset:32
    ds_read_b64_tr_b16 v[102:103], v8 offset:32
    ds_read_b64_tr_b16 v[104:105], v7 offset:64
    ds_read_b64_tr_b16 v[106:107], v8 offset:64
    s_waitcnt lgkmcnt(6)
    v_mfma_f32_16x16x32_bf16 v[24:27], v[108:111], v[88:91], v[24:27]
    v_mfma_f32_16x16x32_bf16 v[28:31], v[108:111], v[92:95], v[28:31]
    v_mfma_f32_16x16x32_bf16 v[40:43], v[112:115], v[88:91], v[40:43]
    v_mfma_f32_16x16x32_bf16 v[44:47], v[112:115], v[92:95], v[44:47]
    v_mfma_f32_16x16x32_bf16 v[56:59], v[116:119], v[88:91], v[56:59]
    v_mfma_f32_16x16x32_bf16 v[60:63], v[116:119], v[92:95], v[60:63]
    buffer_load_dwordx4 v[88:91], v3, s[32:35], s40 offen offset:2048 sc1
    buffer_load_dwordx4 v[92:95], v3, s[32:35], s40 offen offset:2304 sc1
    s_add_u32 s40, s40, 4096
    ds_read_b64_tr_b16 v[108:109], v7 offset:12416
    ds_read_b64_tr_b16 v[110:111], v8 offset:12416
    ds_read_b64_tr_b16 v[112:113], v7 offset:12448
    ds_read_b64_tr_b16 v[114:115], v8 offset:12448
    ds_read_b64_tr_b16 v[116:117], v7 offset:12480
    ds_read_b64_tr_b16 v[118:119], v8 offset:12480
    s_waitcnt vmcnt(6) lgkmcnt(6)
    v_mfma_f32_16x16x32_bf16 v[16:19], v[96:99], v[64:67], v[16:19]
    v_mfma_f32_16x16x32_bf16 v[20:23], v[96:99], v[68:71], v[20:23]
    v_mfma_f32_16x16x32_bf16 v[32:35], v[100:103], v[64:67], v[32:35]
    v_mfma_f32_16x16x32_bf16 v[36:39], v[100:103], v[68:71], v[36:39]
    v_mfma_f32_16x16x32_bf16 v[48:51], v[104:107], v[64:67], v[48:51]
    v_mfma_f32_16x16x32_bf16 v[52:55], v[104:107], v[68:71], v[52:55]
    ds_read_b64_tr_b16 v[96:97], v7 offset:3072
    ds_read_b64_tr_b16 v[98:99], v8 offset:3072
    ds_read_b64_tr_b16 v[100:101], v7 offset:3104
    ds_read_b64_tr_b16 v[102:103], v8 offset:3104
    ds_read_b64_tr_b16 v[104:105], v7 offset:3136
    ds_read_b64_tr_b16 v[106:107], v8 offset:3136
    s_waitcnt lgkmcnt(6)
    v_mfma_f32_16x16x32_bf16 v[24:27], v[108:111], v[64:67], v[24:27]
    v_mfma_f32_16x16x32_bf16 v[28:31], v[108:111], v[68:71], v[28:31]
    v_mfma_f32_16x16x32_bf16 v[40:43], v[112:115], v[64:67], v[40:43]
    v_mfma_f32_16x16x32_bf16 v[44:47], v[112:115], v[68:71], v[44:47]
    v_mfma_f32_16x16x32_bf16 v[56:59], v[116:119], v[64:67], v[56:59]
    v_mfma_f32_16x16x32_bf16 v[60:63], v[116:119], v[68:71], v[60:63]
    buffer_load_dwordx4 v[64:67], v3, s[32:35], s40 offen offset:0 sc1
    buffer_load_dwordx4 v[68:71], v3, s[32:35], s40 offen offset:256 sc1
    ds_read_b64_tr_b16 v[108:109], v7 offset:15488
    ds_read_b64_tr_b16 v[110:111], v8 offset:15488
    ds_read_b64_tr_b16 v[112:113], v7 offset:15520
    ds_read_b64_tr_b16 v[114:115], v8 offset:15520
    ds_read_b64_tr_b16 v[116:117], v7 offset:15552
    ds_read_b64_tr_b16 v[118:119], v8 offset:15552
    s_waitcnt vmcnt(6) lgkmcnt(6)
    v_mfma_f32_16x16x32_bf16 v[16:19], v[96:99], v[72:75], v[16:19]
    v_mfma_f32_16x16x32_bf16 v[20:23], v[96:99], v[76:79], v[20:23]
    v_mfma_f32_16x16x32_bf16 v[32:35], v[100:103], v[72:75], v[32:35]
    v_mfma_f32_16x16x32_bf16 v[36:39], v[100:103], v[76:79], v[36:39]
    v_mfma_f32_16x16x32_bf16 v[48:51], v[104:107], v[72:75], v[48:51]
    v_mfma_f32_16x16x32_bf16 v[52:55], v[104:107], v[76:79], v[52:55]
    ds_read_b64_tr_b16 v[96:97], v7 offset:6144
    ds_read_b64_tr_b16 v[98:99], v8 offset:6144
    ds_read_b64_tr_b16 v[100:101], v7 offset:6176
    ds_read_b64_tr_b16 v[102:103], v8 offset:6176
    ds_read_b64_tr_b16 v[104:105], v7 offset:6208
    ds_read_b64_tr_b16 v[106:107], v8 offset:6208
    s_waitcnt lgkmcnt(6)
    v_mfma_f32_16x16x32_bf16 v[24:27], v[108:111], v[72:75], v[24:27]
    v_mfma_f32_16x16x32_bf16 v[28:31], v[108:111], v[76:79], v[28:31]
    v_mfma_f32_16x16x32_bf16 v[40:43], v[112:115], v[72:75], v[40:43]
    v_mfma_f32_16x16x32_bf16 v[44:47], v[112:115], v[76:79], v[44:47]
    v_mfma_f32_16x16x32_bf16 v[56:59], v[116:119], v[72:75], v[56:59]
    v_mfma_f32_16x16x32_bf16 v[60:63], v[116:119], v[76:79], v[60:63]
    buffer_load_dwordx4 v[72:75], v3, s[32:35], s40 offen offset:2048 sc1
    buffer_load_dwordx4 v[76:79], v3, s[32:35], s40 offen offset:2304 sc1
    s_add_u32 s40, s40, 4096
    ds_read_b64_tr_b16 v[108:109], v7 offset:18560
    ds_read_b64_tr_b16 v[110:111], v8 offset:18560
    ds_read_b64_tr_b16 v[112:113], v7 offset:18592
    ds_read_b64_tr_b16 v[114:115], v8 offset:18592
    ds_read_b64_tr_b16 v[116:117], v7 offset:18624
    ds_read_b64_tr_b16 v[118:119], v8 offset:18624
    s_waitcnt vmcnt(6) lgkmcnt(6)
    v_mfma_f32_16x16x32_bf16 v[16:19], v[96:99], v[80:83], v[16:19]
    v_mfma_f32_16x16x32_bf16 v[20:23], v[96:99], v[84:87], v[20:23]
    v_mfma_f32_16x16x32_bf16 v[32:35], v[100:103], v[80:83], v[32:35]
    v_mfma_f32_16x16x32_bf16 v[36:39], v[100:103], v[84:87], v[36:39]
    v_mfma_f32_16x16x32_bf16 v[48:51], v[104:107], v[80:83], v[48:51]
    v_mfma_f32_16x16x32_bf16 v[52:55], v[104:107], v[84:87], v[52:55]
    ds_read_b64_tr_b16 v[96:97], v7 offset:9216
    ds_read_b64_tr_b16 v[98:99], v8 offset:9216
    ds_read_b64_tr_b16 v[100:101], v7 offset:9248
    ds_read_b64_tr_b16 v[102:103], v8 offset:9248
    ds_read_b64_tr_b16 v[104:105], v7 offset:9280
    ds_read_b64_tr_b16 v[106:107], v8 offset:9280
    s_waitcnt lgkmcnt(6)
    v_mfma_f32_16x16x32_bf16 v[24:27], v[108:111], v[80:83], v[24:27]
    v_mfma_f32_16x16x32_bf16 v[28:31], v[108:111], v[84:87], v[28:31]
    v_mfma_f32_16x16x32_bf16 v[40:43], v[112:115], v[80:83], v[40:43]
    v_mfma_f32_16x16x32_bf16 v[44:47], v[112:115], v[84:87], v[44:47]
    v_mfma_f32_16x16x32_bf16 v[56:59], v[116:119], v[80:83], v[56:59]
    v_mfma_f32_16x16x32_bf16 v[60:63], v[116:119], v[84:87], v[60:63]
    buffer_load_dwordx4 v[80:83], v3, s[32:35], s40 offen offset:0 sc1
    buffer_load_dwordx4 v[84:87], v3, s[32:35], s40 offen offset:256 sc1
    ds_read_b64_tr_b16 v[108:109], v7 offset:21632
    ds_read_b64_tr_b16 v[110:111], v8 offset:21632
    ds_read_b64_tr_b16 v[112:113], v7 offset:21664
    ds_read_b64_tr_b16 v[114:115], v8 offset:21664
    ds_read_b64_tr_b16 v[116:117], v7 offset:21696
    ds_read_b64_tr_b16 v[118:119], v8 offset:21696
    s_waitcnt vmcnt(6) lgkmcnt(6)
    v_mfma_f32_16x16x32_bf16 v[16:19], v[96:99], v[88:91], v[16:19]
    v_mfma_f32_16x16x32_bf16 v[20:23], v[96:99], v[92:95], v[20:23]
    v_mfma_f32_16x16x32_bf16 v[32:35], v[100:103], v[88:91], v[32:35]
    v_mfma_f32_16x16x32_bf16 v[36:39], v[100:103], v[92:95], v[36:39]
    v_mfma_f32_16x16x32_bf16 v[48:51], v[104:107], v[88:91], v[48:51]
    v_mfma_f32_16x16x32_bf16 v[52:55], v[104:107], v[92:95], v[52:55]
    s_waitcnt lgkmcnt(0)
    s_barrier
    ds_read_b64_tr_b16 v[96:97], v7 offset:24832
    ds_read_b64_tr_b16 v[98:99], v8 offset:24832
    ds_read_b64_tr_b16 v[100:101], v7 offset:24864
    ds_read_b64_tr_b16 v[102:103], v8 offset:24864
    ds_read_b64_tr_b16 v[104:105], v7 offset:24896
    ds_read_b64_tr_b16 v[106:107], v8 offset:24896
    s_waitcnt lgkmcnt(6)
    v_mfma_f32_16x16x32_bf16 v[24:27], v[108:111], v[88:91], v[24:27]
    v_mfma_f32_16x16x32_bf16 v[28:31], v[108:111], v[92:95], v[28:31]
    v_mfma_f32_16x16x32_bf16 v[40:43], v[112:115], v[88:91], v[40:43]
    v_mfma_f32_16x16x32_bf16 v[44:47], v[112:115], v[92:95], v[44:47]
    v_mfma_f32_16x16x32_bf16 v[56:59], v[116:119], v[88:91], v[56:59]
    v_mfma_f32_16x16x32_bf16 v[60:63], v[116:119], v[92:95], v[60:63]
    buffer_load_dwordx4 v[88:91], v3, s[32:35], s40 offen offset:2048 sc1
    buffer_load_dwordx4 v[92:95], v3, s[32:35], s40 offen offset:2304 sc1
    s_add_u32 s40, s40, 4096
    ds_read_b64_tr_b16 v[108:109], v7 offset:37248
    ds_read_b64_tr_b16 v[110:111], v8 offset:37248
    ds_read_b64_tr_b16 v[112:113], v7 offset:37280
    ds_read_b64_tr_b16 v[114:115], v8 offset:37280
    ds_read_b64_tr_b16 v[116:117], v7 offset:37312
    ds_read_b64_tr_b16 v[118:119], v8 offset:37312
    s_waitcnt vmcnt(6) lgkmcnt(6)
    v_mfma_f32_16x16x32_bf16 v[16:19], v[96:99], v[64:67], v[16:19]
    v_mfma_f32_16x16x32_bf16 v[20:23], v[96:99], v[68:71], v[20:23]
    v_mfma_f32_16x16x32_bf16 v[32:35], v[100:103], v[64:67], v[32:35]
    v_mfma_f32_16x16x32_bf16 v[36:39], v[100:103], v[68:71], v[36:39]
    v_mfma_f32_16x16x32_bf16 v[48:51], v[104:107], v[64:67], v[48:51]
    v_mfma_f32_16x16x32_bf16 v[52:55], v[104:107], v[68:71], v[52:55]
    ds_read_b64_tr_b16 v[96:97], v7 offset:27904
    ds_read_b64_tr_b16 v[98:99], v8 offset:27904
    ds_read_b64_tr_b16 v[100:101], v7 offset:27936
    ds_read_b64_tr_b16 v[102:103], v8 offset:27936
    ds_read_b64_tr_b16 v[104:105], v7 offset:27968
    ds_read_b64_tr_b16 v[106:107], v8 offset:27968
    s_waitcnt lgkmcnt(6)
    v_mfma_f32_16x16x32_bf16 v[24:27], v[108:111], v[64:67], v[24:27]
    v_mfma_f32_16x16x32_bf16 v[28:31], v[108:111], v[68:71], v[28:31]
    v_mfma_f32_16x16x32_bf16 v[40:43], v[112:115], v[64:67], v[40:43]
    v_mfma_f32_16x16x32_bf16 v[44:47], v[112:115], v[68:71], v[44:47]
    v_mfma_f32_16x16x32_bf16 v[56:59], v[116:119], v[64:67], v[56:59]
    v_mfma_f32_16x16x32_bf16 v[60:63], v[116:119], v[68:71], v[60:63]
    ds_read_b64_tr_b16 v[108:109], v7 offset:40320
    ds_read_b64_tr_b16 v[110:111], v8 offset:40320
    ds_read_b64_tr_b16 v[112:113], v7 offset:40352
    ds_read_b64_tr_b16 v[114:115], v8 offset:40352
    ds_read_b64_tr_b16 v[116:117], v7 offset:40384
    ds_read_b64_tr_b16 v[118:119], v8 offset:40384
    s_waitcnt vmcnt(4) lgkmcnt(6)
    v_mfma_f32_16x16x32_bf16 v[16:19], v[96:99], v[72:75], v[16:19]
    v_mfma_f32_16x16x32_bf16 v[20:23], v[96:99], v[76:79], v[20:23]
    v_mfma_f32_16x16x32_bf16 v[32:35], v[100:103], v[72:75], v[32:35]
    v_mfma_f32_16x16x32_bf16 v[36:39], v[100:103], v[76:79], v[36:39]
    v_mfma_f32_16x16x32_bf16 v[48:51], v[104:107], v[72:75], v[48:51]
    v_mfma_f32_16x16x32_bf16 v[52:55], v[104:107], v[76:79], v[52:55]
    ds_read_b64_tr_b16 v[96:97], v7 offset:30976
    ds_read_b64_tr_b16 v[98:99], v8 offset:30976
    ds_read_b64_tr_b16 v[100:101], v7 offset:31008
    ds_read_b64_tr_b16 v[102:103], v8 offset:31008
    ds_read_b64_tr_b16 v[104:105], v7 offset:31040
    ds_read_b64_tr_b16 v[106:107], v8 offset:31040
    s_waitcnt lgkmcnt(6)
    v_mfma_f32_16x16x32_bf16 v[24:27], v[108:111], v[72:75], v[24:27]
    v_mfma_f32_16x16x32_bf16 v[28:31], v[108:111], v[76:79], v[28:31]
    v_mfma_f32_16x16x32_bf16 v[40:43], v[112:115], v[72:75], v[40:43]
    v_mfma_f32_16x16x32_bf16 v[44:47], v[112:115], v[76:79], v[44:47]
    v_mfma_f32_16x16x32_bf16 v[56:59], v[116:119], v[72:75], v[56:59]
    v_mfma_f32_16x16x32_bf16 v[60:63], v[116:119], v[76:79], v[60:63]
    ds_read_b64_tr_b16 v[108:109], v7 offset:43392
    ds_read_b64_tr_b16 v[110:111], v8 offset:43392
    ds_read_b64_tr_b16 v[112:113], v7 offset:43424
    ds_read_b64_tr_b16 v[114:115], v8 offset:43424
    ds_read_b64_tr_b16 v[116:117], v7 offset:43456
    ds_read_b64_tr_b16 v[118:119], v8 offset:43456
    s_waitcnt vmcnt(2) lgkmcnt(6)
    v_mfma_f32_16x16x32_bf16 v[16:19], v[96:99], v[80:83], v[16:19]
    v_mfma_f32_16x16x32_bf16 v[20:23], v[96:99], v[84:87], v[20:23]
    v_mfma_f32_16x16x32_bf16 v[32:35], v[100:103], v[80:83], v[32:35]
    v_mfma_f32_16x16x32_bf16 v[36:39], v[100:103], v[84:87], v[36:39]
    v_mfma_f32_16x16x32_bf16 v[48:51], v[104:107], v[80:83], v[48:51]
    v_mfma_f32_16x16x32_bf16 v[52:55], v[104:107], v[84:87], v[52:55]
    ds_read_b64_tr_b16 v[96:97], v7 offset:34048
    ds_read_b64_tr_b16 v[98:99], v8 offset:34048
    ds_read_b64_tr_b16 v[100:101], v7 offset:34080
    ds_read_b64_tr_b16 v[102:103], v8 offset:34080
    ds_read_b64_tr_b16 v[104:105], v7 offset:34112
    ds_read_b64_tr_b16 v[106:107], v8 offset:34112
    s_waitcnt lgkmcnt(6)
    v_mfma_f32_16x16x32_bf16 v[24:27], v[108:111], v[80:83], v[24:27]
    v_mfma_f32_16x16x32_bf16 v[28:31], v[108:111], v[84:87], v[28:31]
    v_mfma_f32_16x16x32_bf16 v[40:43], v[112:115], v[80:83], v[40:43]
    v_mfma_f32_16x16x32_bf16 v[44:47], v[112:115], v[84:87], v[44:47]
    v_mfma_f32_16x16x32_bf16 v[56:59], v[116:119], v[80:83], v[56:59]
    v_mfma_f32_16x16x32_bf16 v[60:63], v[116:119], v[84:87], v[60:63]
    ds_read_b64_tr_b16 v[108:109], v7 offset:46464
    ds_read_b64_tr_b16 v[110:111], v8 offset:46464
    ds_read_b64_tr_b16 v[112:113], v7 offset:46496
    ds_read_b64_tr_b16 v[114:115], v8 offset:46496
    ds_read_b64_tr_b16 v[116:117], v7 offset:46528
    ds_read_b64_tr_b16 v[118:119], v8 offset:46528
    s_waitcnt vmcnt(0) lgkmcnt(6)
    v_mfma_f32_16x16x32_bf16 v[16:19], v[96:99], v[88:91], v[16:19]
    v_mfma_f32_16x16x32_bf16 v[20:23], v[96:99], v[92:95], v[20:23]
    v_mfma_f32_16x16x32_bf16 v[32:35], v[100:103], v[88:91], v[32:35]
    v_mfma_f32_16x16x32_bf16 v[36:39], v[100:103], v[92:95], v[36:39]
    v_mfma_f32_16x16x32_bf16 v[48:51], v[104:107], v[88:91], v[48:51]
    v_mfma_f32_16x16x32_bf16 v[52:55], v[104:107], v[92:95], v[52:55]
    s_waitcnt lgkmcnt(0)
    v_mfma_f32_16x16x32_bf16 v[24:27], v[108:111], v[88:91], v[24:27]
    v_mfma_f32_16x16x32_bf16 v[28:31], v[108:111], v[92:95], v[28:31]
    v_mfma_f32_16x16x32_bf16 v[40:43], v[112:115], v[88:91], v[40:43]
    v_mfma_f32_16x16x32_bf16 v[44:47], v[112:115], v[92:95], v[44:47]
    v_mfma_f32_16x16x32_bf16 v[56:59], v[116:119], v[88:91], v[56:59]
    v_mfma_f32_16x16x32_bf16 v[60:63], v[116:119], v[92:95], v[60:63]
    s_setprio 3
    s_mul_i32 s50, s26, 96
    s_mul_i32 s3, s24, 3
    s_add_u32 s50, s50, s3
    s_lshl_b32 s50, s50, 10
    s_add_u32 s50, s50, 10485760
    s_mov_b32 s52, 0xbfb8aa3b
    s_mov_b32 s53, s52
    s_mov_b32 s54, 1.0
    s_mov_b32 s55, 1.0
    v_pk_mul_f32 v[64:65], v[16:17], s[52:53]
    v_pk_mul_f32 v[66:67], v[18:19], s[52:53]
    v_pk_mul_f32 v[68:69], v[20:21], s[52:53]
    v_pk_mul_f32 v[70:71], v[22:23], s[52:53]
    v_exp_f32 v64, v64
    v_exp_f32 v65, v65
    v_exp_f32 v66, v66
    v_exp_f32 v67, v67
    v_exp_f32 v68, v68
    v_exp_f32 v69, v69
    v_exp_f32 v70, v70
    v_exp_f32 v71, v71
    v_pk_add_f32 v[64:65], v[64:65], s[54:55]
    v_pk_add_f32 v[66:67], v[66:67], s[54:55]
    v_pk_add_f32 v[68:69], v[68:69], s[54:55]
    v_pk_add_f32 v[70:71], v[70:71], s[54:55]
    v_rcp_f32 v64, v64
    v_rcp_f32 v65, v65
    v_rcp_f32 v66, v66
    v_rcp_f32 v67, v67
    v_rcp_f32 v68, v68
    v_rcp_f32 v69, v69
    v_rcp_f32 v70, v70
    v_rcp_f32 v71, v71
    v_pk_mul_f32 v[16:17], v[16:17], v[24:25]
    v_pk_mul_f32 v[18:19], v[18:19], v[26:27]
    v_pk_mul_f32 v[20:21], v[20:21], v[28:29]
    v_pk_mul_f32 v[22:23], v[22:23], v[30:31]
    v_pk_mul_f32 v[16:17], v[16:17], v[64:65]
    v_pk_mul_f32 v[18:19], v[18:19], v[66:67]
    v_pk_mul_f32 v[20:21], v[20:21], v[68:69]
    v_pk_mul_f32 v[22:23], v[22:23], v[70:71]
    v_cvt_pk_bf16_f32 v16, v16, v17
    v_cvt_pk_bf16_f32 v17, v18, v19
    v_cvt_pk_bf16_f32 v18, v20, v21
    v_cvt_pk_bf16_f32 v19, v22, v23
    s_nop 1
    v_permlane32_swap_b32 v16, v18
    v_permlane32_swap_b32 v17, v19
    buffer_store_dwordx4 v[16:19], v14, s[32:35], s50 offen offset:0 sc1
    v_pk_mul_f32 v[64:65], v[32:33], s[52:53]
    v_pk_mul_f32 v[66:67], v[34:35], s[52:53]
    v_pk_mul_f32 v[68:69], v[36:37], s[52:53]
    v_pk_mul_f32 v[70:71], v[38:39], s[52:53]
    v_exp_f32 v64, v64
    v_exp_f32 v65, v65
    v_exp_f32 v66, v66
    v_exp_f32 v67, v67
    v_exp_f32 v68, v68
    v_exp_f32 v69, v69
    v_exp_f32 v70, v70
    v_exp_f32 v71, v71
    v_pk_add_f32 v[64:65], v[64:65], s[54:55]
    v_pk_add_f32 v[66:67], v[66:67], s[54:55]
    v_pk_add_f32 v[68:69], v[68:69], s[54:55]
    v_pk_add_f32 v[70:71], v[70:71], s[54:55]
    v_rcp_f32 v64, v64
    v_rcp_f32 v65, v65
    v_rcp_f32 v66, v66
    v_rcp_f32 v67, v67
    v_rcp_f32 v68, v68
    v_rcp_f32 v69, v69
    v_rcp_f32 v70, v70
    v_rcp_f32 v71, v71
    v_pk_mul_f32 v[32:33], v[32:33], v[40:41]
    v_pk_mul_f32 v[34:35], v[34:35], v[42:43]
    v_pk_mul_f32 v[36:37], v[36:37], v[44:45]
    v_pk_mul_f32 v[38:39], v[38:39], v[46:47]
    v_pk_mul_f32 v[32:33], v[32:33], v[64:65]
    v_pk_mul_f32 v[34:35], v[34:35], v[66:67]
    v_pk_mul_f32 v[36:37], v[36:37], v[68:69]
    v_pk_mul_f32 v[38:39], v[38:39], v[70:71]
    v_cvt_pk_bf16_f32 v32, v32, v33
    v_cvt_pk_bf16_f32 v33, v34, v35
    v_cvt_pk_bf16_f32 v34, v36, v37
    v_cvt_pk_bf16_f32 v35, v38, v39
    s_nop 1
    v_permlane32_swap_b32 v32, v34
    v_permlane32_swap_b32 v33, v35
    buffer_store_dwordx4 v[32:35], v14, s[32:35], s50 offen offset:1024 sc1
    v_pk_mul_f32 v[64:65], v[48:49], s[52:53]
    v_pk_mul_f32 v[66:67], v[50:51], s[52:53]
    v_pk_mul_f32 v[68:69], v[52:53], s[52:53]
    v_pk_mul_f32 v[70:71], v[54:55], s[52:53]
    v_exp_f32 v64, v64
    v_exp_f32 v65, v65
    v_exp_f32 v66, v66
    v_exp_f32 v67, v67
    v_exp_f32 v68, v68
    v_exp_f32 v69, v69
    v_exp_f32 v70, v70
    v_exp_f32 v71, v71
    v_pk_add_f32 v[64:65], v[64:65], s[54:55]
    v_pk_add_f32 v[66:67], v[66:67], s[54:55]
    v_pk_add_f32 v[68:69], v[68:69], s[54:55]
    v_pk_add_f32 v[70:71], v[70:71], s[54:55]
    v_rcp_f32 v64, v64
    v_rcp_f32 v65, v65
    v_rcp_f32 v66, v66
    v_rcp_f32 v67, v67
    v_rcp_f32 v68, v68
    v_rcp_f32 v69, v69
    v_rcp_f32 v70, v70
    v_rcp_f32 v71, v71
    v_pk_mul_f32 v[48:49], v[48:49], v[56:57]
    v_pk_mul_f32 v[50:51], v[50:51], v[58:59]
    v_pk_mul_f32 v[52:53], v[52:53], v[60:61]
    v_pk_mul_f32 v[54:55], v[54:55], v[62:63]
    v_pk_mul_f32 v[48:49], v[48:49], v[64:65]
    v_pk_mul_f32 v[50:51], v[50:51], v[66:67]
    v_pk_mul_f32 v[52:53], v[52:53], v[68:69]
    v_pk_mul_f32 v[54:55], v[54:55], v[70:71]
    v_cvt_pk_bf16_f32 v48, v48, v49
    v_cvt_pk_bf16_f32 v49, v50, v51
    v_cvt_pk_bf16_f32 v50, v52, v53
    v_cvt_pk_bf16_f32 v51, v54, v55
    s_nop 1
    v_permlane32_swap_b32 v48, v50
    v_permlane32_swap_b32 v49, v51
    buffer_store_dwordx4 v[48:51], v14, s[32:35], s50 offen offset:2048 sc1
    s_lshl_b32 s63, s27, 5
    s_add_u32 s63, s63, s24
    s_and_b32 s3, s2, 255
    s_and_b32 s24, s3, 7
    s_lshr_b32 s26, s3, 3
    s_lshr_b32 s27, s24, 1
    s_lshl_b32 s27, s27, 3
    s_and_b32 s3, s26, 7
    s_add_u32 s27, s27, s3
    s_and_b32 s24, s24, 1
    s_lshl_b32 s24, s24, 2
    s_lshr_b32 s26, s26, 3
    s_add_u32 s24, s24, s26
    s_mov_b32 s28, s16
    s_mov_b32 s29, s17
    s_mov_b32 s30, 1966080
    s_mov_b32 s31, 0x00020000
    s_mov_b32 s36, s8
    s_mov_b32 s37, s9
    s_mov_b32 s38, 819200
    s_mov_b32 s39, 0x00020000
    s_and_b32 s46, s25, 1
    s_lshr_b32 s47, s25, 1
    s_mov_b32 s56, s25
    s_lshl_b32 s26, s27, 1
    s_add_u32 s26, s26, s46
    s_lshl_b32 s3, s47, 11
    s_mul_i32 s40, s26, 98304
    s_add_u32 s40, s40, s3
    s_add_u32 s40, s40, 10485760
    s_mul_i32 s43, s26, 40960
    s_add_u32 s43, s43, s3
    s_add_u32 s43, s43, 16777216
    s_mul_i32 s41, s24, 160
    s_mul_i32 s3, s25, 40960
    s_add_u32 s41, s41, s3
    s_mov_b32 s44, s41
    s_mul_i32 s49, s25, 5120
    s_and_b32 s3, s25, 3
    s_mul_i32 s42, s3, 5120
    s_lshr_b32 s48, s25, 2
    v_lshrrev_b32 v10, 4, v2
    v_and_b32 v14, 15, v2
    v_lshlrev_b32 v3, 4, v14
    v_lshl_add_u32 v3, v10, 9, v3
    s_movk_i32 s3, 1280
    v_add_u32 v11, 0, v2
    v_mul_u32_u24 v12, 6554, v11
    v_lshrrev_b32 v12, 16, v12
    v_mul_u32_u24 v13, 10, v12
    v_sub_u32 v13, v11, v13
    v_lshlrev_b32 v13, 4, v13
    v_mad_u32_u24 v4, v12, s3, v13
    v_add_u32 v11, 64, v2
    v_mul_u32_u24 v12, 6554, v11
    v_lshrrev_b32 v12, 16, v12
    v_mul_u32_u24 v13, 10, v12
    v_sub_u32 v13, v11, v13
    v_lshlrev_b32 v13, 4, v13
    v_mad_u32_u24 v5, v12, s3, v13
    v_add_u32 v11, 128, v2
    v_mul_u32_u24 v12, 6554, v11
    v_lshrrev_b32 v12, 16, v12
    v_mul_u32_u24 v13, 10, v12
    v_sub_u32 v13, v11, v13
    v_lshlrev_b32 v13, 4, v13
    v_mad_u32_u24 v6, v12, s3, v13
    v_add_u32 v11, 192, v2
    v_mul_u32_u24 v12, 6554, v11
    v_lshrrev_b32 v12, 16, v12
    v_mul_u32_u24 v13, 10, v12
    v_sub_u32 v13, v11, v13
    v_lshlrev_b32 v13, 4, v13
    v_mad_u32_u24 v7, v12, s3, v13
    v_add_u32 v11, 256, v2
    v_mul_u32_u24 v12, 6554, v11
    v_lshrrev_b32 v12, 16, v12
    v_mul_u32_u24 v13, 10, v12
    v_sub_u32 v13, v11, v13
    v_lshlrev_b32 v13, 4, v13
    v_mad_u32_u24 v8, v12, s3, v13
    s_lshl_b32 s45, s26, 5
    v_add_u32 v14, s45, v14
    v_mul_u32_u24 v14, 1280, v14
    v_and_b32 v11, 1, v10
    v_lshl_add_u32 v14, v11, 4, v14
    v_lshrrev_b32 v11, 1, v10
    v_lshl_add_u32 v14, v11, 3, v14
    s_mul_i32 s45, s24, 160
    v_add_u32 v14, s45, v14
    v_bfe_u32 v10, v2, 2, 2
    v_bfe_u32 v15, v2, 4, 1
    v_lshrrev_b32 v1, 5, v2
    v_and_b32 v0, 1, v2
    v_lshlrev_b32 v0, 4, v0
    v_bfe_u32 v11, v2, 1, 1
    v_lshl_add_u32 v0, v11, 3, v0
    s_movk_i32 s3, 160
    v_lshl_add_u32 v11, v1, 4, v10
    v_lshl_add_u32 v11, v15, 2, v11
    v_mad_u32_u24 v11, v11, s3, v0
    s_mul_i32 s45, s47, 5120
    v_add_u32 v11, s45, v11
    v_mul_u32_u24 v12, 20, v1
    v_lshl_add_u32 v12, v15, 2, v12
    v_add_u32 v12, v12, v10
    v_mad_u32_u24 v12, v12, s3, v0
    s_mul_i32 s45, s47, 6400
    v_add_u32 v12, s45, v12
    v_mul_u32_u24 v13, 80, v1
    v_mul_u32_u24 v15, 20, v15
    v_add3_u32 v13, v13, v15, v10
    v_mad_u32_u24 v13, v13, s3, v0
    v_add_u32 v13, 2560, v13
    s_waitcnt vmcnt(0)
    s_barrier
    s_cmp_lg_u32 s25, 0
    s_cbranch_scc1 L_w027
    s_lshl_b32 s62, s63, 7
    s_add_u32 s62, s62, 21168128
    v_mov_b32 v0, 0
    v_mov_b32 v56, s60
    v_mov_b32 v57, s61
    s_mov_b64 exec, 1
    buffer_store_dwordx2 v[56:57], v0, s[32:35], s62 offen sc1
    s_mov_b64 exec, -1
L_w027:
    s_cmp_lg_u32 s48, 0
    s_cbranch_scc1 L_dwd28
    s_add_u32 m0, s42, 0
    s_nop 0
    buffer_load_dwordx4 v4, s[28:31], s41 offen lds
    s_add_u32 m0, s42, 1024
    s_nop 0
    buffer_load_dwordx4 v5, s[28:31], s41 offen lds
    s_add_u32 m0, s42, 2048
    s_nop 0
    buffer_load_dwordx4 v6, s[28:31], s41 offen lds
    s_add_u32 m0, s42, 3072
    s_nop 0
    buffer_load_dwordx4 v7, s[28:31], s41 offen lds
    s_add_u32 m0, s42, 4096
    s_nop 0
    buffer_load_dwordx4 v8, s[28:31], s41 offen lds
    s_add_u32 s41, s41, 327680
L_dwd28:
    s_cmp_lg_u32 s48, 1
    s_cbranch_scc1 L_dwd29
    s_add_u32 m0, s42, 20480
    s_nop 0
    buffer_load_dwordx4 v4, s[28:31], s41 offen lds
    s_add_u32 m0, s42, 21504
    s_nop 0
    buffer_load_dwordx4 v5, s[28:31], s41 offen lds
    s_add_u32 m0, s42, 22528
    s_nop 0
    buffer_load_dwordx4 v6, s[28:31], s41 offen lds
    s_add_u32 m0, s42, 23552
    s_nop 0
    buffer_load_dwordx4 v7, s[28:31], s41 offen lds
    s_add_u32 m0, s42, 24576
    s_nop 0
    buffer_load_dwordx4 v8, s[28:31], s41 offen lds
    s_add_u32 s41, s41, 327680
L_dwd29:
    s_cmp_lg_u32 s48, 0
    s_cbranch_scc1 L_dwd30
    s_add_u32 m0, s42, 40960
    s_nop 0
    buffer_load_dwordx4 v4, s[28:31], s41 offen lds
    s_add_u32 m0, s42, 41984
    s_nop 0
    buffer_load_dwordx4 v5, s[28:31], s41 offen lds
    s_add_u32 m0, s42, 43008
    s_nop 0
    buffer_load_dwordx4 v6, s[28:31], s41 offen lds
    s_add_u32 m0, s42, 44032
    s_nop 0
    buffer_load_dwordx4 v7, s[28:31], s41 offen lds
    s_add_u32 m0, s42, 45056
    s_nop 0
    buffer_load_dwordx4 v8, s[28:31], s41 offen lds
    s_add_u32 s41, s41, 327680
L_dwd30:
    s_cmp_lg_u32 s48, 1
    s_cbranch_scc1 L_dwd31
    s_add_u32 m0, s42, 61440
    s_nop 0
    buffer_load_dwordx4 v4, s[28:31], s41 offen lds
    s_add_u32 m0, s42, 62464
    s_nop 0
    buffer_load_dwordx4 v5, s[28:31], s41 offen lds
    s_add_u32 m0, s42, 63488
    s_nop 0
    buffer_load_dwordx4 v6, s[28:31], s41 offen lds
    s_add_u32 m0, s42, 64512
    s_nop 0
    buffer_load_dwordx4 v7, s[28:31], s41 offen lds
    s_add_u32 m0, s42, 65536
    s_nop 0
    buffer_load_dwordx4 v8, s[28:31], s41 offen lds
    s_add_u32 s41, s41, 327680
L_dwd31:
    v_mov_b32 v16, 0
    v_mov_b32 v17, 0
    v_mov_b32 v18, 0
    v_mov_b32 v19, 0
    v_mov_b32 v20, 0
    v_mov_b32 v21, 0
    v_mov_b32 v22, 0
    v_mov_b32 v23, 0
    v_mov_b32 v24, 0
    v_mov_b32 v25, 0
    v_mov_b32 v26, 0
    v_mov_b32 v27, 0
    v_mov_b32 v28, 0
    v_mov_b32 v29, 0
    v_mov_b32 v30, 0
    v_mov_b32 v31, 0
    v_mov_b32 v32, 0
    v_mov_b32 v33, 0
    v_mov_b32 v34, 0
    v_mov_b32 v35, 0
    v_mov_b32 v36, 0
    v_mov_b32 v37, 0
    v_mov_b32 v38, 0
    v_mov_b32 v39, 0
    v_mov_b32 v40, 0
    v_mov_b32 v41, 0
    v_mov_b32 v42, 0
    v_mov_b32 v43, 0
    v_mov_b32 v44, 0
    v_mov_b32 v45, 0
    v_mov_b32 v46, 0
    v_mov_b32 v47, 0
    v_mov_b32 v48, 0
    v_mov_b32 v49, 0
    v_mov_b32 v50, 0
    v_mov_b32 v51, 0
    v_mov_b32 v52, 0
    v_mov_b32 v53, 0
    v_mov_b32 v54, 0
    v_mov_b32 v55, 0
    s_cmp_lg_u32 s25, 0
    s_cbranch_scc1 L_w032
    s_lshr_b32 s63, s27, 2
    s_lshl_b32 s63, s63, 5
    v_and_b32 v0, 31, v2
    v_add_u32 v0, s63, v0
    v_lshlrev_b32 v0, 7, v0
    v_add_u32 v0, 21168128, v0
    s_mov_b32 s83, 0x40000
L_poll33_2:
    buffer_load_dwordx2 v[56:57], v0, s[32:35], 0 offen sc1
    s_waitcnt vmcnt(0)
    v_cmp_ne_u64 vcc, s[60:61], v[56:57]
    s_cbranch_vccz L_poll33_ok
    s_mov_b64 exec, vcc
    s_sleep 1
    s_sub_u32 s83, s83, 1
    s_cbranch_scc0 L_poll33_2
L_poll33_ok:
    s_mov_b64 exec, -1
L_w032:
    s_barrier
    s_setprio 0
    buffer_load_dwordx4 v[56:59], v3, s[32:35], s40 offen offset:0 sc1
    buffer_load_dwordx4 v[60:63], v3, s[32:35], s40 offen offset:256 sc1
    s_add_u32 s40, s40, 8192
    buffer_load_dwordx4 v[64:67], v3, s[32:35], s40 offen offset:0 sc1
    buffer_load_dwordx4 v[68:71], v3, s[32:35], s40 offen offset:256 sc1
    s_add_u32 s40, s40, 8192
    v_add_u32 v15, 40960, v11
    s_waitcnt vmcnt(9)
    s_barrier
    ds_read_b64_tr_b16 v[88:89], v11 offset:0
    ds_read_b64_tr_b16 v[90:91], v11 offset:1280
    ds_read_b64_tr_b16 v[92:93], v11 offset:32
    ds_read_b64_tr_b16 v[94:95], v11 offset:1312
    ds_read_b64_tr_b16 v[96:97], v11 offset:64
    ds_read_b64_tr_b16 v[98:99], v11 offset:1344
    ds_read_b64_tr_b16 v[100:101], v11 offset:96
    ds_read_b64_tr_b16 v[102:103], v11 offset:1376
    ds_read_b64_tr_b16 v[104:105], v11 offset:128
    ds_read_b64_tr_b16 v[106:107], v11 offset:1408
    s_waitcnt lgkmcnt(0)
    s_barrier
    ds_read_b64_tr_b16 v[108:109], v11 offset:20480
    ds_read_b64_tr_b16 v[110:111], v11 offset:21760
    ds_read_b64_tr_b16 v[112:113], v11 offset:20512
    ds_read_b64_tr_b16 v[114:115], v11 offset:21792
    ds_read_b64_tr_b16 v[116:117], v11 offset:20544
    ds_read_b64_tr_b16 v[118:119], v11 offset:21824
    ds_read_b64_tr_b16 v[120:121], v11 offset:20576
    ds_read_b64_tr_b16 v[122:123], v11 offset:21856
    ds_read_b64_tr_b16 v[124:125], v11 offset:20608
    ds_read_b64_tr_b16 v[126:127], v11 offset:21888
    s_cmp_lg_u32 s48, 0
    s_cbranch_scc1 L_dwd34
    s_add_u32 m0, s42, 0
    s_nop 0
    buffer_load_dwordx4 v4, s[28:31], s41 offen lds
    s_add_u32 m0, s42, 1024
    s_nop 0
    buffer_load_dwordx4 v5, s[28:31], s41 offen lds
    s_add_u32 m0, s42, 2048
    s_nop 0
    buffer_load_dwordx4 v6, s[28:31], s41 offen lds
    s_add_u32 m0, s42, 3072
    s_nop 0
    buffer_load_dwordx4 v7, s[28:31], s41 offen lds
    s_add_u32 m0, s42, 4096
    s_nop 0
    buffer_load_dwordx4 v8, s[28:31], s41 offen lds
    s_add_u32 s41, s41, 327680
L_dwd34:
    s_waitcnt vmcnt(2)
    v_mfma_f32_16x16x32_bf16 v[16:19], v[88:91], v[56:59], v[16:19]
    v_mfma_f32_16x16x32_bf16 v[36:39], v[88:91], v[60:63], v[36:39]
    v_mfma_f32_16x16x32_bf16 v[20:23], v[92:95], v[56:59], v[20:23]
    v_mfma_f32_16x16x32_bf16 v[40:43], v[92:95], v[60:63], v[40:43]
    v_mfma_f32_16x16x32_bf16 v[24:27], v[96:99], v[56:59], v[24:27]
    v_mfma_f32_16x16x32_bf16 v[44:47], v[96:99], v[60:63], v[44:47]
    v_mfma_f32_16x16x32_bf16 v[28:31], v[100:103], v[56:59], v[28:31]
    v_mfma_f32_16x16x32_bf16 v[48:51], v[100:103], v[60:63], v[48:51]
    v_mfma_f32_16x16x32_bf16 v[32:35], v[104:107], v[56:59], v[32:35]
    v_mfma_f32_16x16x32_bf16 v[52:55], v[104:107], v[60:63], v[52:55]
    buffer_load_dwordx4 v[72:75], v3, s[32:35], s40 offen offset:0 sc1
    buffer_load_dwordx4 v[76:79], v3, s[32:35], s40 offen offset:256 sc1
    s_add_u32 s40, s40, 8192
    buffer_load_dwordx4 v[80:83], v3, s[32:35], s40 offen offset:0 sc1
    buffer_load_dwordx4 v[84:87], v3, s[32:35], s40 offen offset:256 sc1
    s_add_u32 s40, s40, 8192
    s_waitcnt lgkmcnt(0)
    s_barrier
    ds_read_b64_tr_b16 v[88:89], v15 offset:0
    ds_read_b64_tr_b16 v[90:91], v15 offset:1280
    ds_read_b64_tr_b16 v[92:93], v15 offset:32
    ds_read_b64_tr_b16 v[94:95], v15 offset:1312
    ds_read_b64_tr_b16 v[96:97], v15 offset:64
    ds_read_b64_tr_b16 v[98:99], v15 offset:1344
    ds_read_b64_tr_b16 v[100:101], v15 offset:96
    ds_read_b64_tr_b16 v[102:103], v15 offset:1376
    ds_read_b64_tr_b16 v[104:105], v15 offset:128
    ds_read_b64_tr_b16 v[106:107], v15 offset:1408
    s_cmp_lg_u32 s48, 1
    s_cbranch_scc1 L_dwd35
    s_add_u32 m0, s42, 20480
    s_nop 0
    buffer_load_dwordx4 v4, s[28:31], s41 offen lds
    s_add_u32 m0, s42, 21504
    s_nop 0
    buffer_load_dwordx4 v5, s[28:31], s41 offen lds
    s_add_u32 m0, s42, 22528
    s_nop 0
    buffer_load_dwordx4 v6, s[28:31], s41 offen lds
    s_add_u32 m0, s42, 23552
    s_nop 0
    buffer_load_dwordx4 v7, s[28:31], s41 offen lds
    s_add_u32 m0, s42, 24576
    s_nop 0
    buffer_load_dwordx4 v8, s[28:31], s41 offen lds
    s_add_u32 s41, s41, 327680
L_dwd35:
    s_waitcnt vmcnt(9)
    v_mfma_f32_16x16x32_bf16 v[16:19], v[108:111], v[64:67], v[16:19]
    v_mfma_f32_16x16x32_bf16 v[36:39], v[108:111], v[68:71], v[36:39]
    v_mfma_f32_16x16x32_bf16 v[20:23], v[112:115], v[64:67], v[20:23]
    v_mfma_f32_16x16x32_bf16 v[40:43], v[112:115], v[68:71], v[40:43]
    v_mfma_f32_16x16x32_bf16 v[24:27], v[116:119], v[64:67], v[24:27]
    v_mfma_f32_16x16x32_bf16 v[44:47], v[116:119], v[68:71], v[44:47]
    v_mfma_f32_16x16x32_bf16 v[28:31], v[120:123], v[64:67], v[28:31]
    v_mfma_f32_16x16x32_bf16 v[48:51], v[120:123], v[68:71], v[48:51]
    v_mfma_f32_16x16x32_bf16 v[32:35], v[124:127], v[64:67], v[32:35]
    v_mfma_f32_16x16x32_bf16 v[52:55], v[124:127], v[68:71], v[52:55]
    buffer_load_dwordx4 v[56:59], v3, s[32:35], s40 offen offset:0 sc1
    buffer_load_dwordx4 v[60:63], v3, s[32:35], s40 offen offset:256 sc1
    s_add_u32 s40, s40, 8192
    buffer_load_dwordx4 v[64:67], v3, s[32:35], s40 offen offset:0 sc1
    buffer_load_dwordx4 v[68:71], v3, s[32:35], s40 offen offset:256 sc1
    s_add_u32 s40, s40, 8192
    s_waitcnt lgkmcnt(0)
    s_barrier
    ds_read_b64_tr_b16 v[108:109], v15 offset:20480
    ds_read_b64_tr_b16 v[110:111], v15 offset:21760
    ds_read_b64_tr_b16 v[112:113], v15 offset:20512
    ds_read_b64_tr_b16 v[114:115], v15 offset:21792
    ds_read_b64_tr_b16 v[116:117], v15 offset:20544
    ds_read_b64_tr_b16 v[118:119], v15 offset:21824
    ds_read_b64_tr_b16 v[120:121], v15 offset:20576
    ds_read_b64_tr_b16 v[122:123], v15 offset:21856
    ds_read_b64_tr_b16 v[124:125], v15 offset:20608
    ds_read_b64_tr_b16 v[126:127], v15 offset:21888
    s_cmp_lg_u32 s48, 0
    s_cbranch_scc1 L_dwd36
    s_add_u32 m0, s42, 40960
    s_nop 0
    buffer_load_dwordx4 v4, s[28:31], s41 offen lds
    s_add_u32 m0, s42, 41984
    s_nop 0
    buffer_load_dwordx4 v5, s[28:31], s41 offen lds
    s_add_u32 m0, s42, 43008
    s_nop 0
    buffer_load_dwordx4 v6, s[28:31], s41 offen lds
    s_add_u32 m0, s42, 44032
    s_nop 0
    buffer_load_dwordx4 v7, s[28:31], s41 offen lds
    s_add_u32 m0, s42, 45056
    s_nop 0
    buffer_load_dwordx4 v8, s[28:31], s41 offen lds
    s_add_u32 s41, s41, 327680
L_dwd36:
    s_waitcnt vmcnt(11)
    v_mfma_f32_16x16x32_bf16 v[16:19], v[88:91], v[72:75], v[16:19]
    v_mfma_f32_16x16x32_bf16 v[36:39], v[88:91], v[76:79], v[36:39]
    v_mfma_f32_16x16x32_bf16 v[20:23], v[92:95], v[72:75], v[20:23]
    v_mfma_f32_16x16x32_bf16 v[40:43], v[92:95], v[76:79], v[40:43]
    v_mfma_f32_16x16x32_bf16 v[24:27], v[96:99], v[72:75], v[24:27]
    v_mfma_f32_16x16x32_bf16 v[44:47], v[96:99], v[76:79], v[44:47]
    v_mfma_f32_16x16x32_bf16 v[28:31], v[100:103], v[72:75], v[28:31]
    v_mfma_f32_16x16x32_bf16 v[48:51], v[100:103], v[76:79], v[48:51]
    v_mfma_f32_16x16x32_bf16 v[32:35], v[104:107], v[72:75], v[32:35]
    v_mfma_f32_16x16x32_bf16 v[52:55], v[104:107], v[76:79], v[52:55]
    buffer_load_dwordx4 v[72:75], v3, s[32:35], s40 offen offset:0 sc1
    buffer_load_dwordx4 v[76:79], v3, s[32:35], s40 offen offset:256 sc1
    s_add_u32 s40, s40, 8192
    s_waitcnt lgkmcnt(0)
    s_barrier
    ds_read_b64_tr_b16 v[88:89], v11 offset:0
    ds_read_b64_tr_b16 v[90:91], v11 offset:1280
    ds_read_b64_tr_b16 v[92:93], v11 offset:32
    ds_read_b64_tr_b16 v[94:95], v11 offset:1312
    ds_read_b64_tr_b16 v[96:97], v11 offset:64
    ds_read_b64_tr_b16 v[98:99], v11 offset:1344
    ds_read_b64_tr_b16 v[100:101], v11 offset:96
    ds_read_b64_tr_b16 v[102:103], v11 offset:1376
    ds_read_b64_tr_b16 v[104:105], v11 offset:128
    ds_read_b64_tr_b16 v[106:107], v11 offset:1408
    s_cmp_lg_u32 s48, 1
    s_cbranch_scc1 L_dwd37
    s_add_u32 m0, s42, 61440
    s_nop 0
    buffer_load_dwordx4 v4, s[28:31], s41 offen lds
    s_add_u32 m0, s42, 62464
    s_nop 0
    buffer_load_dwordx4 v5, s[28:31], s41 offen lds
    s_add_u32 m0, s42, 63488
    s_nop 0
    buffer_load_dwordx4 v6, s[28:31], s41 offen lds
    s_add_u32 m0, s42, 64512
    s_nop 0
    buffer_load_dwordx4 v7, s[28:31], s41 offen lds
    s_add_u32 m0, s42, 65536
    s_nop 0
    buffer_load_dwordx4 v8, s[28:31], s41 offen lds
    s_add_u32 s41, s41, 327680
L_dwd37:
    s_waitcnt vmcnt(11)
    v_mfma_f32_16x16x32_bf16 v[16:19], v[108:111], v[80:83], v[16:19]
    v_mfma_f32_16x16x32_bf16 v[36:39], v[108:111], v[84:87], v[36:39]
    v_mfma_f32_16x16x32_bf16 v[20:23], v[112:115], v[80:83], v[20:23]
    v_mfma_f32_16x16x32_bf16 v[40:43], v[112:115], v[84:87], v[40:43]
    v_mfma_f32_16x16x32_bf16 v[24:27], v[116:119], v[80:83], v[24:27]
    v_mfma_f32_16x16x32_bf16 v[44:47], v[116:119], v[84:87], v[44:47]
    v_mfma_f32_16x16x32_bf16 v[28:31], v[120:123], v[80:83], v[28:31]
    v_mfma_f32_16x16x32_bf16 v[48:51], v[120:123], v[84:87], v[48:51]
    v_mfma_f32_16x16x32_bf16 v[32:35], v[124:127], v[80:83], v[32:35]
    v_mfma_f32_16x16x32_bf16 v[52:55], v[124:127], v[84:87], v[52:55]
    buffer_load_dwordx4 v[80:83], v3, s[32:35], s40 offen offset:0 sc1
    buffer_load_dwordx4 v[84:87], v3, s[32:35], s40 offen offset:256 sc1
    s_add_u32 s40, s40, 8192
    s_waitcnt lgkmcnt(0)
    s_barrier
    ds_read_b64_tr_b16 v[108:109], v11 offset:20480
    ds_read_b64_tr_b16 v[110:111], v11 offset:21760
    ds_read_b64_tr_b16 v[112:113], v11 offset:20512
    ds_read_b64_tr_b16 v[114:115], v11 offset:21792
    ds_read_b64_tr_b16 v[116:117], v11 offset:20544
    ds_read_b64_tr_b16 v[118:119], v11 offset:21824
    ds_read_b64_tr_b16 v[120:121], v11 offset:20576
    ds_read_b64_tr_b16 v[122:123], v11 offset:21856
    ds_read_b64_tr_b16 v[124:125], v11 offset:20608
    ds_read_b64_tr_b16 v[126:127], v11 offset:21888
    s_cmp_lg_u32 s48, 0
    s_cbranch_scc1 L_dwd38
    s_add_u32 m0, s42, 0
    s_nop 0
    buffer_load_dwordx4 v4, s[28:31], s41 offen lds
    s_add_u32 m0, s42, 1024
    s_nop 0
    buffer_load_dwordx4 v5, s[28:31], s41 offen lds
    s_add_u32 m0, s42, 2048
    s_nop 0
    buffer_load_dwordx4 v6, s[28:31], s41 offen lds
    s_add_u32 m0, s42, 3072
    s_nop 0
    buffer_load_dwordx4 v7, s[28:31], s41 offen lds
    s_add_u32 m0, s42, 4096
    s_nop 0
    buffer_load_dwordx4 v8, s[28:31], s41 offen lds
    s_add_u32 s41, s41, 327680
L_dwd38:
    s_waitcnt vmcnt(11)
    v_mfma_f32_16x16x32_bf16 v[16:19], v[88:91], v[56:59], v[16:19]
    v_mfma_f32_16x16x32_bf16 v[36:39], v[88:91], v[60:63], v[36:39]
    v_mfma_f32_16x16x32_bf16 v[20:23], v[92:95], v[56:59], v[20:23]
    v_mfma_f32_16x16x32_bf16 v[40:43], v[92:95], v[60:63], v[40:43]
    v_mfma_f32_16x16x32_bf16 v[24:27], v[96:99], v[56:59], v[24:27]
    v_mfma_f32_16x16x32_bf16 v[44:47], v[96:99], v[60:63], v[44:47]
    v_mfma_f32_16x16x32_bf16 v[28:31], v[100:103], v[56:59], v[28:31]
    v_mfma_f32_16x16x32_bf16 v[48:51], v[100:103], v[60:63], v[48:51]
    v_mfma_f32_16x16x32_bf16 v[32:35], v[104:107], v[56:59], v[32:35]
    v_mfma_f32_16x16x32_bf16 v[52:55], v[104:107], v[60:63], v[52:55]
    buffer_load_dwordx4 v[56:59], v3, s[32:35], s40 offen offset:0 sc1
    buffer_load_dwordx4 v[60:63], v3, s[32:35], s40 offen offset:256 sc1
    s_add_u32 s40, s40, 8192
    s_waitcnt vmcnt(11) lgkmcnt(0)
    s_barrier
    ds_read_b64_tr_b16 v[88:89], v15 offset:0
    ds_read_b64_tr_b16 v[90:91], v15 offset:1280
    ds_read_b64_tr_b16 v[92:93], v15 offset:32
    ds_read_b64_tr_b16 v[94:95], v15 offset:1312
    ds_read_b64_tr_b16 v[96:97], v15 offset:64
    ds_read_b64_tr_b16 v[98:99], v15 offset:1344
    ds_read_b64_tr_b16 v[100:101], v15 offset:96
    ds_read_b64_tr_b16 v[102:103], v15 offset:1376
    ds_read_b64_tr_b16 v[104:105], v15 offset:128
    ds_read_b64_tr_b16 v[106:107], v15 offset:1408
    s_cmp_lg_u32 s48, 1
    s_cbranch_scc1 L_dwd39
    s_add_u32 m0, s42, 20480
    s_nop 0
    buffer_load_dwordx4 v4, s[28:31], s41 offen lds
    s_add_u32 m0, s42, 21504
    s_nop 0
    buffer_load_dwordx4 v5, s[28:31], s41 offen lds
    s_add_u32 m0, s42, 22528
    s_nop 0
    buffer_load_dwordx4 v6, s[28:31], s41 offen lds
    s_add_u32 m0, s42, 23552
    s_nop 0
    buffer_load_dwordx4 v7, s[28:31], s41 offen lds
    s_add_u32 m0, s42, 24576
    s_nop 0
    buffer_load_dwordx4 v8, s[28:31], s41 offen lds
    s_add_u32 s41, s41, 327680
L_dwd39:
    v_mfma_f32_16x16x32_bf16 v[16:19], v[108:111], v[64:67], v[16:19]
    v_mfma_f32_16x16x32_bf16 v[36:39], v[108:111], v[68:71], v[36:39]
    v_mfma_f32_16x16x32_bf16 v[20:23], v[112:115], v[64:67], v[20:23]
    v_mfma_f32_16x16x32_bf16 v[40:43], v[112:115], v[68:71], v[40:43]
    v_mfma_f32_16x16x32_bf16 v[24:27], v[116:119], v[64:67], v[24:27]
    v_mfma_f32_16x16x32_bf16 v[44:47], v[116:119], v[68:71], v[44:47]
    v_mfma_f32_16x16x32_bf16 v[28:31], v[120:123], v[64:67], v[28:31]
    v_mfma_f32_16x16x32_bf16 v[48:51], v[120:123], v[68:71], v[48:51]
    v_mfma_f32_16x16x32_bf16 v[32:35], v[124:127], v[64:67], v[32:35]
    v_mfma_f32_16x16x32_bf16 v[52:55], v[124:127], v[68:71], v[52:55]
    buffer_load_dwordx4 v[64:67], v3, s[32:35], s40 offen offset:0 sc1
    buffer_load_dwordx4 v[68:71], v3, s[32:35], s40 offen offset:256 sc1
    s_add_u32 s40, s40, 8192
    s_waitcnt vmcnt(11) lgkmcnt(0)
    s_barrier
    ds_read_b64_tr_b16 v[108:109], v15 offset:20480
    ds_read_b64_tr_b16 v[110:111], v15 offset:21760
    ds_read_b64_tr_b16 v[112:113], v15 offset:20512
    ds_read_b64_tr_b16 v[114:115], v15 offset:21792
    ds_read_b64_tr_b16 v[116:117], v15 offset:20544
    ds_read_b64_tr_b16 v[118:119], v15 offset:21824
    ds_read_b64_tr_b16 v[120:121], v15 offset:20576
    ds_read_b64_tr_b16 v[122:123], v15 offset:21856
    ds_read_b64_tr_b16 v[124:125], v15 offset:20608
    ds_read_b64_tr_b16 v[126:127], v15 offset:21888
    s_cmp_lg_u32 s48, 0
    s_cbranch_scc1 L_dwd40
    s_add_u32 m0, s42, 40960
    s_nop 0
    buffer_load_dwordx4 v4, s[28:31], s41 offen lds
    s_add_u32 m0, s42, 41984
    s_nop 0
    buffer_load_dwordx4 v5, s[28:31], s41 offen lds
    s_add_u32 m0, s42, 43008
    s_nop 0
    buffer_load_dwordx4 v6, s[28:31], s41 offen lds
    s_add_u32 m0, s42, 44032
    s_nop 0
    buffer_load_dwordx4 v7, s[28:31], s41 offen lds
    s_add_u32 m0, s42, 45056
    s_nop 0
    buffer_load_dwordx4 v8, s[28:31], s41 offen lds
    s_add_u32 s41, s41, 327680
L_dwd40:
    v_mfma_f32_16x16x32_bf16 v[16:19], v[88:91], v[72:75], v[16:19]
    v_mfma_f32_16x16x32_bf16 v[36:39], v[88:91], v[76:79], v[36:39]
    v_mfma_f32_16x16x32_bf16 v[20:23], v[92:95], v[72:75], v[20:23]
    v_mfma_f32_16x16x32_bf16 v[40:43], v[92:95], v[76:79], v[40:43]
    v_mfma_f32_16x16x32_bf16 v[24:27], v[96:99], v[72:75], v[24:27]
    v_mfma_f32_16x16x32_bf16 v[44:47], v[96:99], v[76:79], v[44:47]
    v_mfma_f32_16x16x32_bf16 v[28:31], v[100:103], v[72:75], v[28:31]
    v_mfma_f32_16x16x32_bf16 v[48:51], v[100:103], v[76:79], v[48:51]
    v_mfma_f32_16x16x32_bf16 v[32:35], v[104:107], v[72:75], v[32:35]
    v_mfma_f32_16x16x32_bf16 v[52:55], v[104:107], v[76:79], v[52:55]
    buffer_load_dwordx4 v[72:75], v3, s[32:35], s40 offen offset:0 sc1
    buffer_load_dwordx4 v[76:79], v3, s[32:35], s40 offen offset:256 sc1
    s_add_u32 s40, s40, 8192
    s_waitcnt vmcnt(11) lgkmcnt(0)
    s_barrier
    ds_read_b64_tr_b16 v[88:89], v11 offset:0
    ds_read_b64_tr_b16 v[90:91], v11 offset:1280
    ds_read_b64_tr_b16 v[92:93], v11 offset:32
    ds_read_b64_tr_b16 v[94:95], v11 offset:1312
    ds_read_b64_tr_b16 v[96:97], v11 offset:64
    ds_read_b64_tr_b16 v[98:99], v11 offset:1344
    ds_read_b64_tr_b16 v[100:101], v11 offset:96
    ds_read_b64_tr_b16 v[102:103], v11 offset:1376
    ds_read_b64_tr_b16 v[104:105], v11 offset:128
    ds_read_b64_tr_b16 v[106:107], v11 offset:1408
    s_cmp_lg_u32 s48, 1
    s_cbranch_scc1 L_dwd41
    s_add_u32 m0, s42, 61440
    s_nop 0
    buffer_load_dwordx4 v4, s[28:31], s41 offen lds
    s_add_u32 m0, s42, 62464
    s_nop 0
    buffer_load_dwordx4 v5, s[28:31], s41 offen lds
    s_add_u32 m0, s42, 63488
    s_nop 0
    buffer_load_dwordx4 v6, s[28:31], s41 offen lds
    s_add_u32 m0, s42, 64512
    s_nop 0
    buffer_load_dwordx4 v7, s[28:31], s41 offen lds
    s_add_u32 m0, s42, 65536
    s_nop 0
    buffer_load_dwordx4 v8, s[28:31], s41 offen lds
    s_add_u32 s41, s41, 327680
L_dwd41:
    v_mfma_f32_16x16x32_bf16 v[16:19], v[108:111], v[80:83], v[16:19]
    v_mfma_f32_16x16x32_bf16 v[36:39], v[108:111], v[84:87], v[36:39]
    v_mfma_f32_16x16x32_bf16 v[20:23], v[112:115], v[80:83], v[20:23]
    v_mfma_f32_16x16x32_bf16 v[40:43], v[112:115], v[84:87], v[40:43]
    v_mfma_f32_16x16x32_bf16 v[24:27], v[116:119], v[80:83], v[24:27]
    v_mfma_f32_16x16x32_bf16 v[44:47], v[116:119], v[84:87], v[44:47]
    v_mfma_f32_16x16x32_bf16 v[28:31], v[120:123], v[80:83], v[28:31]
    v_mfma_f32_16x16x32_bf16 v[48:51], v[120:123], v[84:87], v[48:51]
    v_mfma_f32_16x16x32_bf16 v[32:35], v[124:127], v[80:83], v[32:35]
    v_mfma_f32_16x16x32_bf16 v[52:55], v[124:127], v[84:87], v[52:55]
    buffer_load_dwordx4 v[80:83], v3, s[32:35], s40 offen offset:0 sc1
    buffer_load_dwordx4 v[84:87], v3, s[32:35], s40 offen offset:256 sc1
    s_add_u32 s40, s40, 8192
    s_waitcnt vmcnt(11) lgkmcnt(0)
    s_barrier
    ds_read_b64_tr_b16 v[108:109], v11 offset:20480
    ds_read_b64_tr_b16 v[110:111], v11 offset:21760
    ds_read_b64_tr_b16 v[112:113], v11 offset:20512
    ds_read_b64_tr_b16 v[114:115], v11 offset:21792
    ds_read_b64_tr_b16 v[116:117], v11 offset:20544
    ds_read_b64_tr_b16 v[118:119], v11 offset:21824
    ds_read_b64_tr_b16 v[120:121], v11 offset:20576
    ds_read_b64_tr_b16 v[122:123], v11 offset:21856
    ds_read_b64_tr_b16 v[124:125], v11 offset:20608
    ds_read_b64_tr_b16 v[126:127], v11 offset:21888
    v_mfma_f32_16x16x32_bf16 v[16:19], v[88:91], v[56:59], v[16:19]
    v_mfma_f32_16x16x32_bf16 v[36:39], v[88:91], v[60:63], v[36:39]
    v_mfma_f32_16x16x32_bf16 v[20:23], v[92:95], v[56:59], v[20:23]
    v_mfma_f32_16x16x32_bf16 v[40:43], v[92:95], v[60:63], v[40:43]
    v_mfma_f32_16x16x32_bf16 v[24:27], v[96:99], v[56:59], v[24:27]
    v_mfma_f32_16x16x32_bf16 v[44:47], v[96:99], v[60:63], v[44:47]
    v_mfma_f32_16x16x32_bf16 v[28:31], v[100:103], v[56:59], v[28:31]
    v_mfma_f32_16x16x32_bf16 v[48:51], v[100:103], v[60:63], v[48:51]
    v_mfma_f32_16x16x32_bf16 v[32:35], v[104:107], v[56:59], v[32:35]
    v_mfma_f32_16x16x32_bf16 v[52:55], v[104:107], v[60:63], v[52:55]
    s_waitcnt vmcnt(4) lgkmcnt(0)
    s_barrier
    ds_read_b64_tr_b16 v[88:89], v15 offset:0
    ds_read_b64_tr_b16 v[90:91], v15 offset:1280
    ds_read_b64_tr_b16 v[92:93], v15 offset:32
    ds_read_b64_tr_b16 v[94:95], v15 offset:1312
    ds_read_b64_tr_b16 v[96:97], v15 offset:64
    ds_read_b64_tr_b16 v[98:99], v15 offset:1344
    ds_read_b64_tr_b16 v[100:101], v15 offset:96
    ds_read_b64_tr_b16 v[102:103], v15 offset:1376
    ds_read_b64_tr_b16 v[104:105], v15 offset:128
    ds_read_b64_tr_b16 v[106:107], v15 offset:1408
    s_waitcnt vmcnt(0)
    s_add_u32 s3, s44, 0
    s_add_u32 m0, s49, 0
    s_nop 0
    buffer_load_dwordx4 v4, s[36:39], s3 offen lds
    s_add_u32 m0, s49, 1024
    s_nop 0
    buffer_load_dwordx4 v5, s[36:39], s3 offen lds
    s_add_u32 m0, s49, 2048
    s_nop 0
    buffer_load_dwordx4 v6, s[36:39], s3 offen lds
    s_add_u32 m0, s49, 3072
    s_nop 0
    buffer_load_dwordx4 v7, s[36:39], s3 offen lds
    s_add_u32 m0, s49, 4096
    s_nop 0
    buffer_load_dwordx4 v8, s[36:39], s3 offen lds
L_wod42:
    v_mfma_f32_16x16x32_bf16 v[16:19], v[108:111], v[64:67], v[16:19]
    v_mfma_f32_16x16x32_bf16 v[36:39], v[108:111], v[68:71], v[36:39]
    v_mfma_f32_16x16x32_bf16 v[20:23], v[112:115], v[64:67], v[20:23]
    v_mfma_f32_16x16x32_bf16 v[40:43], v[112:115], v[68:71], v[40:43]
    v_mfma_f32_16x16x32_bf16 v[24:27], v[116:119], v[64:67], v[24:27]
    v_mfma_f32_16x16x32_bf16 v[44:47], v[116:119], v[68:71], v[44:47]
    v_mfma_f32_16x16x32_bf16 v[28:31], v[120:123], v[64:67], v[28:31]
    v_mfma_f32_16x16x32_bf16 v[48:51], v[120:123], v[68:71], v[48:51]
    v_mfma_f32_16x16x32_bf16 v[32:35], v[124:127], v[64:67], v[32:35]
    v_mfma_f32_16x16x32_bf16 v[52:55], v[124:127], v[68:71], v[52:55]
    s_waitcnt lgkmcnt(0)
    s_barrier
    ds_read_b64_tr_b16 v[108:109], v15 offset:20480
    ds_read_b64_tr_b16 v[110:111], v15 offset:21760
    ds_read_b64_tr_b16 v[112:113], v15 offset:20512
    ds_read_b64_tr_b16 v[114:115], v15 offset:21792
    ds_read_b64_tr_b16 v[116:117], v15 offset:20544
    ds_read_b64_tr_b16 v[118:119], v15 offset:21824
    ds_read_b64_tr_b16 v[120:121], v15 offset:20576
    ds_read_b64_tr_b16 v[122:123], v15 offset:21856
    ds_read_b64_tr_b16 v[124:125], v15 offset:20608
    ds_read_b64_tr_b16 v[126:127], v15 offset:21888
    s_cmp_ge_u32 s25, 4
    s_cbranch_scc1 L_wod43
    s_add_u32 s3, s44, 327680
    s_add_u32 m0, s49, 40960
    s_nop 0
    buffer_load_dwordx4 v4, s[36:39], s3 offen lds
    s_add_u32 m0, s49, 41984
    s_nop 0
    buffer_load_dwordx4 v5, s[36:39], s3 offen lds
    s_add_u32 m0, s49, 43008
    s_nop 0
    buffer_load_dwordx4 v6, s[36:39], s3 offen lds
    s_add_u32 m0, s49, 44032
    s_nop 0
    buffer_load_dwordx4 v7, s[36:39], s3 offen lds
    s_add_u32 m0, s49, 45056
    s_nop 0
    buffer_load_dwordx4 v8, s[36:39], s3 offen lds
L_wod43:
    v_mfma_f32_16x16x32_bf16 v[16:19], v[88:91], v[72:75], v[16:19]
    v_mfma_f32_16x16x32_bf16 v[36:39], v[88:91], v[76:79], v[36:39]
    v_mfma_f32_16x16x32_bf16 v[20:23], v[92:95], v[72:75], v[20:23]
    v_mfma_f32_16x16x32_bf16 v[40:43], v[92:95], v[76:79], v[40:43]
    v_mfma_f32_16x16x32_bf16 v[24:27], v[96:99], v[72:75], v[24:27]
    v_mfma_f32_16x16x32_bf16 v[44:47], v[96:99], v[76:79], v[44:47]
    v_mfma_f32_16x16x32_bf16 v[28:31], v[100:103], v[72:75], v[28:31]
    v_mfma_f32_16x16x32_bf16 v[48:51], v[100:103], v[76:79], v[48:51]
    v_mfma_f32_16x16x32_bf16 v[32:35], v[104:107], v[72:75], v[32:35]
    v_mfma_f32_16x16x32_bf16 v[52:55], v[104:107], v[76:79], v[52:55]
    s_waitcnt lgkmcnt(0)
    v_mfma_f32_16x16x32_bf16 v[16:19], v[108:111], v[80:83], v[16:19]
    v_mfma_f32_16x16x32_bf16 v[36:39], v[108:111], v[84:87], v[36:39]
    v_mfma_f32_16x16x32_bf16 v[20:23], v[112:115], v[80:83], v[20:23]
    v_mfma_f32_16x16x32_bf16 v[40:43], v[112:115], v[84:87], v[40:43]
    v_mfma_f32_16x16x32_bf16 v[24:27], v[116:119], v[80:83], v[24:27]
    v_mfma_f32_16x16x32_bf16 v[44:47], v[116:119], v[84:87], v[44:47]
    v_mfma_f32_16x16x32_bf16 v[28:31], v[120:123], v[80:83], v[28:31]
    v_mfma_f32_16x16x32_bf16 v[48:51], v[120:123], v[84:87], v[48:51]
    v_mfma_f32_16x16x32_bf16 v[32:35], v[124:127], v[80:83], v[32:35]
    v_mfma_f32_16x16x32_bf16 v[52:55], v[124:127], v[84:87], v[52:55]
    s_setprio 3
    s_waitcnt vmcnt(5)
    s_cmp_lt_u32 s25, 4
    s_cbranch_scc1 L_fin_p0
    s_waitcnt vmcnt(0)
L_fin_p0:
    s_barrier
    s_cmp_lt_u32 s25, 4
    s_cbranch_scc1 L_wod44
    s_cmp_ge_u32 s25, 7
    s_cbranch_scc1 L_wod44
    s_add_u32 s3, s44, 327680
    s_add_u32 m0, s49, 40960
    s_nop 0
    buffer_load_dwordx4 v4, s[36:39], s3 offen lds
    s_add_u32 m0, s49, 41984
    s_nop 0
    buffer_load_dwordx4 v5, s[36:39], s3 offen lds
    s_add_u32 m0, s49, 43008
    s_nop 0
    buffer_load_dwordx4 v6, s[36:39], s3 offen lds
    s_add_u32 m0, s49, 44032
    s_nop 0
    buffer_load_dwordx4 v7, s[36:39], s3 offen lds
    s_add_u32 m0, s49, 45056
    s_nop 0
    buffer_load_dwordx4 v8, s[36:39], s3 offen lds
L_wod44:
    ds_read_b64_tr_b16 v[108:109], v12 offset:0
    ds_read_b64_tr_b16 v[110:111], v12 offset:1280
    ds_read_b64_tr_b16 v[112:113], v12 offset:32
    ds_read_b64_tr_b16 v[114:115], v12 offset:1312
    ds_read_b64_tr_b16 v[116:117], v12 offset:64
    ds_read_b64_tr_b16 v[118:119], v12 offset:1344
    ds_read_b64_tr_b16 v[120:121], v12 offset:96
    ds_read_b64_tr_b16 v[122:123], v12 offset:1376
    ds_read_b64_tr_b16 v[124:125], v12 offset:128
    ds_read_b64_tr_b16 v[126:127], v12 offset:1408
    s_cmp_lg_u32 s47, 0
    s_cbranch_scc1 L_fin_p1
    ds_read_b64_tr_b16 v[88:89], v13 offset:0
    ds_read_b64_tr_b16 v[90:91], v13 offset:6400
    ds_read_b64_tr_b16 v[92:93], v13 offset:32
    ds_read_b64_tr_b16 v[94:95], v13 offset:6432
    ds_read_b64_tr_b16 v[96:97], v13 offset:64
    ds_read_b64_tr_b16 v[98:99], v13 offset:6464
    ds_read_b64_tr_b16 v[100:101], v13 offset:96
    ds_read_b64_tr_b16 v[102:103], v13 offset:6496
    ds_read_b64_tr_b16 v[104:105], v13 offset:128
    ds_read_b64_tr_b16 v[106:107], v13 offset:6528
L_fin_p1:
    s_cmp_eq_u32 s47, 3
    s_cselect_b32 s3, 0, s47
    s_mul_i32 s3, s3, 25600
    v_add_u32 v13, s3, v13
    s_waitcnt lgkmcnt(0)
    s_barrier
    s_cmp_ge_u32 s25, 5
    s_cbranch_scc1 L_wod45
    s_add_u32 s3, s44, 614400
    s_add_u32 m0, s49, 0
    s_nop 0
    buffer_load_dwordx4 v4, s[36:39], s3 offen lds
    s_add_u32 m0, s49, 1024
    s_nop 0
    buffer_load_dwordx4 v5, s[36:39], s3 offen lds
    s_add_u32 m0, s49, 2048
    s_nop 0
    buffer_load_dwordx4 v6, s[36:39], s3 offen lds
    s_add_u32 m0, s49, 3072
    s_nop 0
    buffer_load_dwordx4 v7, s[36:39], s3 offen lds
    s_add_u32 m0, s49, 4096
    s_nop 0
    buffer_load_dwordx4 v8, s[36:39], s3 offen lds
L_wod45:
    s_mov_b32 s28, s4
    s_mov_b32 s29, s5
    s_mov_b32 s30, 2621440
    s_mov_b32 s31, 0x00020000
    s_lshl_b32 s52, s47, 5
    s_add_u32 s53, s52, 20480
    s_movk_i32 s54, 128
    s_movk_i32 s55, 20608
    v_lshrrev_b32 v15, 5, v2
    v_and_b32 v10, 15, v2
    v_lshl_add_u32 v15, v15, 4, v10
    s_lshl_b32 s3, s26, 5
    v_add_u32 v15, s3, v15
    v_mul_u32_u24 v15, 1280, v15
    v_bfe_u32 v10, v2, 4, 1
    v_lshl_add_u32 v15, v10, 4, v15
    s_mul_i32 s3, s24, 160
    v_add_u32 v15, s3, v15
    buffer_load_dwordx2 v[0:1], v14, s[28:31], s52 offen
    s_setprio 3
    s_cmp_lg_u32 s25, 0
    s_cbranch_scc1 L_w046
    v_and_b32 v58, 31, v2
    v_add_u32 v58, s63, v58
    v_lshlrev_b32 v58, 7, v58
    v_add_u32 v58, 21233664, v58
    s_mov_b32 s83, 0x40000
    s_mov_b64 exec, 1
L_poll47:
    buffer_load_dwordx2 v[56:57], v58, s[32:35], 0 offen sc1
    s_waitcnt vmcnt(0)
    v_cmp_ne_u64 vcc, s[60:61], v[56:57]
    s_cbranch_vccz L_poll47_1
    s_sleep 2
    s_sub_u32 s83, s83, 1
    s_cbranch_scc0 L_poll47
L_poll47_1:
    s_mov_b64 exec, -2
L_poll47_2:
    buffer_load_dwordx2 v[56:57], v58, s[32:35], 0 offen sc1
    s_waitcnt vmcnt(0)
    v_cmp_ne_u64 vcc, s[60:61], v[56:57]
    s_cbranch_vccz L_poll47_ok
    s_mov_b64 exec, vcc
    s_sleep 1
    s_sub_u32 s83, s83, 1
    s_cbranch_scc0 L_poll47_2
L_poll47_ok:
    s_mov_b64 exec, -1
L_w046:
    s_waitcnt vmcnt(0)
    s_barrier
    s_add_u32 s3, s43, 32768
    buffer_load_dwordx4 v[56:59], v3, s[32:35], s3 offen offset:0 sc1
    buffer_load_dwordx4 v[60:63], v3, s[32:35], s3 offen offset:256 sc1
    s_add_u32 s3, s43, 0
    buffer_load_dwordx4 v[64:67], v3, s[32:35], s3 offen offset:0 sc1
    buffer_load_dwordx4 v[68:71], v3, s[32:35], s3 offen offset:256 sc1
    s_add_u32 s3, s43, 8192
    buffer_load_dwordx4 v[72:75], v3, s[32:35], s3 offen offset:0 sc1
    buffer_load_dwordx4 v[76:79], v3, s[32:35], s3 offen offset:256 sc1
    s_add_u32 s3, s43, 16384
    buffer_load_dwordx4 v[80:83], v3, s[32:35], s3 offen offset:0 sc1
    buffer_load_dwordx4 v[84:87], v3, s[32:35], s3 offen offset:256 sc1
    s_add_u32 s3, s43, 24576
    buffer_load_dwordx4 v[4:7], v3, s[32:35], s3 offen offset:0 sc1
    buffer_load_dwordx4 v[8:11], v3, s[32:35], s3 offen offset:256 sc1
    s_mov_b32 s36, s18
    s_mov_b32 s37, s19
    s_mov_b32 s38, 2621440
    s_mov_b32 s39, 0x00020000
    s_cmp_eq_u32 s47, 0
    s_cbranch_scc1 L_fin_r4
    ds_read_b64_tr_b16 v[88:89], v13 offset:0
    ds_read_b64_tr_b16 v[90:91], v13 offset:6400
    ds_read_b64_tr_b16 v[92:93], v13 offset:32
    ds_read_b64_tr_b16 v[94:95], v13 offset:6432
    ds_read_b64_tr_b16 v[96:97], v13 offset:64
    ds_read_b64_tr_b16 v[98:99], v13 offset:6464
    ds_read_b64_tr_b16 v[100:101], v13 offset:96
    ds_read_b64_tr_b16 v[102:103], v13 offset:6496
    ds_read_b64_tr_b16 v[104:105], v13 offset:128
    ds_read_b64_tr_b16 v[106:107], v13 offset:6528
L_fin_r4:
    s_waitcnt vmcnt(8) lgkmcnt(0)
    v_mfma_f32_16x16x32_bf16 v[16:19], v[88:91], v[56:59], v[16:19]
    v_mfma_f32_16x16x32_bf16 v[36:39], v[88:91], v[60:63], v[36:39]
    v_mfma_f32_16x16x32_bf16 v[20:23], v[92:95], v[56:59], v[20:23]
    v_mfma_f32_16x16x32_bf16 v[40:43], v[92:95], v[60:63], v[40:43]
    v_mfma_f32_16x16x32_bf16 v[24:27], v[96:99], v[56:59], v[24:27]
    v_mfma_f32_16x16x32_bf16 v[44:47], v[96:99], v[60:63], v[44:47]
    v_mfma_f32_16x16x32_bf16 v[28:31], v[100:103], v[56:59], v[28:31]
    v_mfma_f32_16x16x32_bf16 v[48:51], v[100:103], v[60:63], v[48:51]
    v_mfma_f32_16x16x32_bf16 v[32:35], v[104:107], v[56:59], v[32:35]
    v_mfma_f32_16x16x32_bf16 v[52:55], v[104:107], v[60:63], v[52:55]
    ds_read_b64_tr_b16 v[88:89], v12 offset:25600
    ds_read_b64_tr_b16 v[90:91], v12 offset:26880
    ds_read_b64_tr_b16 v[92:93], v12 offset:25632
    ds_read_b64_tr_b16 v[94:95], v12 offset:26912
    ds_read_b64_tr_b16 v[96:97], v12 offset:25664
    ds_read_b64_tr_b16 v[98:99], v12 offset:26944
    ds_read_b64_tr_b16 v[100:101], v12 offset:25696
    ds_read_b64_tr_b16 v[102:103], v12 offset:26976
    ds_read_b64_tr_b16 v[104:105], v12 offset:25728
    ds_read_b64_tr_b16 v[106:107], v12 offset:27008
    s_waitcnt vmcnt(6)
    v_mfma_f32_16x16x32_bf16 v[16:19], v[108:111], v[64:67], v[16:19]
    v_mfma_f32_16x16x32_bf16 v[36:39], v[108:111], v[68:71], v[36:39]
    v_mfma_f32_16x16x32_bf16 v[20:23], v[112:115], v[64:67], v[20:23]
    v_mfma_f32_16x16x32_bf16 v[40:43], v[112:115], v[68:71], v[40:43]
    v_mfma_f32_16x16x32_bf16 v[24:27], v[116:119], v[64:67], v[24:27]
    v_mfma_f32_16x16x32_bf16 v[44:47], v[116:119], v[68:71], v[44:47]
    v_mfma_f32_16x16x32_bf16 v[28:31], v[120:123], v[64:67], v[28:31]
    v_mfma_f32_16x16x32_bf16 v[48:51], v[120:123], v[68:71], v[48:51]
    v_mfma_f32_16x16x32_bf16 v[32:35], v[124:127], v[64:67], v[32:35]
    v_mfma_f32_16x16x32_bf16 v[52:55], v[124:127], v[68:71], v[52:55]
    ds_read_b64_tr_b16 v[108:109], v12 offset:51200
    ds_read_b64_tr_b16 v[110:111], v12 offset:52480
    ds_read_b64_tr_b16 v[112:113], v12 offset:51232
    ds_read_b64_tr_b16 v[114:115], v12 offset:52512
    ds_read_b64_tr_b16 v[116:117], v12 offset:51264
    ds_read_b64_tr_b16 v[118:119], v12 offset:52544
    ds_read_b64_tr_b16 v[120:121], v12 offset:51296
    ds_read_b64_tr_b16 v[122:123], v12 offset:52576
    ds_read_b64_tr_b16 v[124:125], v12 offset:51328
    ds_read_b64_tr_b16 v[126:127], v12 offset:52608
    s_waitcnt vmcnt(4) lgkmcnt(10)
    v_mfma_f32_16x16x32_bf16 v[16:19], v[88:91], v[72:75], v[16:19]
    v_mfma_f32_16x16x32_bf16 v[36:39], v[88:91], v[76:79], v[36:39]
    v_mfma_f32_16x16x32_bf16 v[20:23], v[92:95], v[72:75], v[20:23]
    v_mfma_f32_16x16x32_bf16 v[40:43], v[92:95], v[76:79], v[40:43]
    v_mfma_f32_16x16x32_bf16 v[24:27], v[96:99], v[72:75], v[24:27]
    v_mfma_f32_16x16x32_bf16 v[44:47], v[96:99], v[76:79], v[44:47]
    v_mfma_f32_16x16x32_bf16 v[28:31], v[100:103], v[72:75], v[28:31]
    v_mfma_f32_16x16x32_bf16 v[48:51], v[100:103], v[76:79], v[48:51]
    v_mfma_f32_16x16x32_bf16 v[32:35], v[104:107], v[72:75], v[32:35]
    v_mfma_f32_16x16x32_bf16 v[52:55], v[104:107], v[76:79], v[52:55]
    ds_read_b64_tr_b16 v[88:89], v12 offset:0
    ds_read_b64_tr_b16 v[90:91], v12 offset:1280
    ds_read_b64_tr_b16 v[92:93], v12 offset:32
    ds_read_b64_tr_b16 v[94:95], v12 offset:1312
    ds_read_b64_tr_b16 v[96:97], v12 offset:64
    ds_read_b64_tr_b16 v[98:99], v12 offset:1344
    ds_read_b64_tr_b16 v[100:101], v12 offset:96
    ds_read_b64_tr_b16 v[102:103], v12 offset:1376
    ds_read_b64_tr_b16 v[104:105], v12 offset:128
    ds_read_b64_tr_b16 v[106:107], v12 offset:1408
    s_waitcnt vmcnt(2) lgkmcnt(10)
    v_mfma_f32_16x16x32_bf16 v[16:19], v[108:111], v[80:83], v[16:19]
    v_mfma_f32_16x16x32_bf16 v[36:39], v[108:111], v[84:87], v[36:39]
    v_mfma_f32_16x16x32_bf16 v[20:23], v[112:115], v[80:83], v[20:23]
    v_mfma_f32_16x16x32_bf16 v[40:43], v[112:115], v[84:87], v[40:43]
    v_mfma_f32_16x16x32_bf16 v[24:27], v[116:119], v[80:83], v[24:27]
    v_mfma_f32_16x16x32_bf16 v[44:47], v[116:119], v[84:87], v[44:47]
    v_mfma_f32_16x16x32_bf16 v[28:31], v[120:123], v[80:83], v[28:31]
    v_mfma_f32_16x16x32_bf16 v[48:51], v[120:123], v[84:87], v[48:51]
    v_mfma_f32_16x16x32_bf16 v[32:35], v[124:127], v[80:83], v[32:35]
    v_mfma_f32_16x16x32_bf16 v[52:55], v[124:127], v[84:87], v[52:55]
    buffer_load_dwordx2 v[58:59], v14, s[28:31], s53 offen
    buffer_load_dwordx2 v[60:61], v14, s[28:31], s54 offen
    buffer_load_dwordx2 v[62:63], v14, s[28:31], s55 offen
    s_waitcnt vmcnt(3) lgkmcnt(0)
    s_barrier
    v_mfma_f32_16x16x32_bf16 v[16:19], v[88:91], v[4:7], v[16:19]
    v_mfma_f32_16x16x32_bf16 v[36:39], v[88:91], v[8:11], v[36:39]
    v_mfma_f32_16x16x32_bf16 v[20:23], v[92:95], v[4:7], v[20:23]
    v_mfma_f32_16x16x32_bf16 v[40:43], v[92:95], v[8:11], v[40:43]
    v_mfma_f32_16x16x32_bf16 v[24:27], v[96:99], v[4:7], v[24:27]
    v_mfma_f32_16x16x32_bf16 v[44:47], v[96:99], v[8:11], v[44:47]
    v_mfma_f32_16x16x32_bf16 v[28:31], v[100:103], v[4:7], v[28:31]
    v_mfma_f32_16x16x32_bf16 v[48:51], v[100:103], v[8:11], v[48:51]
    v_mfma_f32_16x16x32_bf16 v[32:35], v[104:107], v[4:7], v[32:35]
    v_mfma_f32_16x16x32_bf16 v[52:55], v[104:107], v[8:11], v[52:55]
    v_lshlrev_b32 v9, 4, v2
    s_mul_i32 s3, s56, 10240
    v_add_u32 v10, s3, v9
    s_cmp_eq_u32 s47, 0
    s_cbranch_scc1 L_fw48
    ds_write_b128 v10, v[16:19] offset:0
    s_branch L_fw48_n
L_fw48:
    v_mov_b32 v64, v16
    v_mov_b32 v65, v17
    v_mov_b32 v66, v18
    v_mov_b32 v67, v19
L_fw48_n:
    s_cmp_eq_u32 s47, 1
    s_cbranch_scc1 L_fw49
    ds_write_b128 v10, v[20:23] offset:1024
    s_branch L_fw49_n
L_fw49:
    v_mov_b32 v64, v20
    v_mov_b32 v65, v21
    v_mov_b32 v66, v22
    v_mov_b32 v67, v23
L_fw49_n:
    s_cmp_eq_u32 s47, 2
    s_cbranch_scc1 L_fw50
    ds_write_b128 v10, v[24:27] offset:2048
    s_branch L_fw50_n
L_fw50:
    v_mov_b32 v64, v24
    v_mov_b32 v65, v25
    v_mov_b32 v66, v26
    v_mov_b32 v67, v27
L_fw50_n:
    s_cmp_eq_u32 s47, 3
    s_cbranch_scc1 L_fw51
    ds_write_b128 v10, v[28:31] offset:3072
    s_branch L_fw51_n
L_fw51:
    v_mov_b32 v64, v28
    v_mov_b32 v65, v29
    v_mov_b32 v66, v30
    v_mov_b32 v67, v31
L_fw51_n:
    s_cmp_eq_u32 s47, 3
    s_cbranch_scc1 L_fw52
    ds_write_b128 v10, v[32:35] offset:4096
    s_branch L_fw52_n
L_fw52:
    v_mov_b32 v96, v32
    v_mov_b32 v97, v33
    v_mov_b32 v98, v34
    v_mov_b32 v99, v35
L_fw52_n:
    s_cmp_eq_u32 s47, 0
    s_cbranch_scc1 L_fw53
    ds_write_b128 v10, v[36:39] offset:5120
    s_branch L_fw53_n
L_fw53:
    v_mov_b32 v80, v36
    v_mov_b32 v81, v37
    v_mov_b32 v82, v38
    v_mov_b32 v83, v39
L_fw53_n:
    s_cmp_eq_u32 s47, 1
    s_cbranch_scc1 L_fw54
    ds_write_b128 v10, v[40:43] offset:6144
    s_branch L_fw54_n
L_fw54:
    v_mov_b32 v80, v40
    v_mov_b32 v81, v41
    v_mov_b32 v82, v42
    v_mov_b32 v83, v43
L_fw54_n:
    s_cmp_eq_u32 s47, 2
    s_cbranch_scc1 L_fw55
    ds_write_b128 v10, v[44:47] offset:7168
    s_branch L_fw55_n
L_fw55:
    v_mov_b32 v80, v44
    v_mov_b32 v81, v45
    v_mov_b32 v82, v46
    v_mov_b32 v83, v47
L_fw55_n:
    s_cmp_eq_u32 s47, 3
    s_cbranch_scc1 L_fw56
    ds_write_b128 v10, v[48:51] offset:8192
    s_branch L_fw56_n
L_fw56:
    v_mov_b32 v80, v48
    v_mov_b32 v81, v49
    v_mov_b32 v82, v50
    v_mov_b32 v83, v51
L_fw56_n:
    s_cmp_eq_u32 s47, 3
    s_cbranch_scc1 L_fw57
    ds_write_b128 v10, v[52:55] offset:9216
    s_branch L_fw57_n
L_fw57:
    v_mov_b32 v112, v52
    v_mov_b32 v113, v53
    v_mov_b32 v114, v54
    v_mov_b32 v115, v55
L_fw57_n:
    s_mul_i32 s3, s46, 10240
    s_lshl_b32 s50, s47, 10
    s_add_u32 s3, s3, s50
    v_add_u32 v10, s3, v9
    s_add_u32 s3, s47, 1
    s_and_b32 s3, s3, 3
    s_mul_i32 s3, s3, 20480
    v_add_u32 v4, s3, v10
    s_add_u32 s3, s47, 2
    s_and_b32 s3, s3, 3
    s_mul_i32 s3, s3, 20480
    v_add_u32 v5, s3, v10
    s_add_u32 s3, s47, 3
    s_and_b32 s3, s3, 3
    s_mul_i32 s3, s3, 20480
    v_add_u32 v6, s3, v10
    s_waitcnt lgkmcnt(0)
    s_barrier
    ds_read_b128 v[68:71], v4 offset:0
    ds_read_b128 v[72:75], v5 offset:0
    ds_read_b128 v[76:79], v6 offset:0
    ds_read_b128 v[84:87], v4 offset:5120
    ds_read_b128 v[88:91], v5 offset:5120
    ds_read_b128 v[92:95], v6 offset:5120
    s_cmp_lg_u32 s47, 3
    s_cbranch_scc1 L_fin_r2
    ds_read_b128 v[100:103], v4 offset:1024
    ds_read_b128 v[104:107], v5 offset:1024
    ds_read_b128 v[108:111], v6 offset:1024
    ds_read_b128 v[116:119], v4 offset:6144
    ds_read_b128 v[120:123], v5 offset:6144
    ds_read_b128 v[124:127], v6 offset:6144
L_fin_r2:
    s_waitcnt vmcnt(0) lgkmcnt(0)
    v_lshlrev_b32 v4, 16, v0
    v_and_b32 v5, 0xffff0000, v0
    v_lshlrev_b32 v6, 16, v1
    v_and_b32 v7, 0xffff0000, v1
    v_pk_add_f32 v[64:65], v[64:65], v[68:69]
    v_pk_add_f32 v[72:73], v[72:73], v[76:77]
    v_pk_add_f32 v[64:65], v[64:65], v[4:5]
    v_pk_add_f32 v[64:65], v[64:65], v[72:73]
    v_pk_add_f32 v[66:67], v[66:67], v[70:71]
    v_pk_add_f32 v[74:75], v[74:75], v[78:79]
    v_pk_add_f32 v[66:67], v[66:67], v[6:7]
    v_pk_add_f32 v[66:67], v[66:67], v[74:75]
    v_cvt_pk_bf16_f32 v68, v64, v65
    v_cvt_pk_bf16_f32 v69, v66, v67
    v_lshlrev_b32 v4, 16, v58
    v_and_b32 v5, 0xffff0000, v58
    v_lshlrev_b32 v6, 16, v59
    v_and_b32 v7, 0xffff0000, v59
    v_pk_add_f32 v[80:81], v[80:81], v[84:85]
    v_pk_add_f32 v[88:89], v[88:89], v[92:93]
    v_pk_add_f32 v[80:81], v[80:81], v[4:5]
    v_pk_add_f32 v[80:81], v[80:81], v[88:89]
    v_pk_add_f32 v[82:83], v[82:83], v[86:87]
    v_pk_add_f32 v[90:91], v[90:91], v[94:95]
    v_pk_add_f32 v[82:83], v[82:83], v[6:7]
    v_pk_add_f32 v[82:83], v[82:83], v[90:91]
    v_cvt_pk_bf16_f32 v70, v80, v81
    v_cvt_pk_bf16_f32 v71, v82, v83
    s_nop 1
    v_permlane32_swap_b32 v68, v70
    v_permlane32_swap_b32 v69, v71
    buffer_store_dwordx4 v[68:71], v15, s[36:39], s52 offen
    s_cmp_lg_u32 s47, 3
    s_cbranch_scc1 L_fin_end
    v_lshlrev_b32 v4, 16, v60
    v_and_b32 v5, 0xffff0000, v60
    v_lshlrev_b32 v6, 16, v61
    v_and_b32 v7, 0xffff0000, v61
    v_pk_add_f32 v[96:97], v[96:97], v[100:101]
    v_pk_add_f32 v[104:105], v[104:105], v[108:109]
    v_pk_add_f32 v[96:97], v[96:97], v[4:5]
    v_pk_add_f32 v[96:97], v[96:97], v[104:105]
    v_pk_add_f32 v[98:99], v[98:99], v[102:103]
    v_pk_add_f32 v[106:107], v[106:107], v[110:111]
    v_pk_add_f32 v[98:99], v[98:99], v[6:7]
    v_pk_add_f32 v[98:99], v[98:99], v[106:107]
    v_cvt_pk_bf16_f32 v100, v96, v97
    v_cvt_pk_bf16_f32 v101, v98, v99
    v_lshlrev_b32 v4, 16, v62
    v_and_b32 v5, 0xffff0000, v62
    v_lshlrev_b32 v6, 16, v63
    v_and_b32 v7, 0xffff0000, v63
    v_pk_add_f32 v[112:113], v[112:113], v[116:117]
    v_pk_add_f32 v[120:121], v[120:121], v[124:125]
    v_pk_add_f32 v[112:113], v[112:113], v[4:5]
    v_pk_add_f32 v[112:113], v[112:113], v[120:121]
    v_pk_add_f32 v[114:115], v[114:115], v[118:119]
    v_pk_add_f32 v[122:123], v[122:123], v[126:127]
    v_pk_add_f32 v[114:115], v[114:115], v[6:7]
    v_pk_add_f32 v[114:115], v[114:115], v[122:123]
    v_cvt_pk_bf16_f32 v102, v112, v113
    v_cvt_pk_bf16_f32 v103, v114, v115
    s_nop 1
    v_permlane32_swap_b32 v100, v102
    v_permlane32_swap_b32 v101, v103
    buffer_store_dwordx4 v[100:103], v15, s[36:39], s54 offen
L_fin_end:
L_end:
    s_endpgm
.section .rodata,"a"
.p2align 6
.amdhsa_kernel parallel_sum__softmax_full_mha__swiglu_ffn__prompt_kernel
  .amdhsa_next_free_vgpr 128
  .amdhsa_next_free_sgpr 96
  .amdhsa_accum_offset 128
  .amdhsa_group_segment_fixed_size 0
  .amdhsa_kernarg_size 80
  .amdhsa_user_sgpr_count 2
  .amdhsa_user_sgpr_kernarg_segment_ptr 1
  .amdhsa_system_sgpr_workgroup_id_x 1
  .amdhsa_float_denorm_mode_32 3
.end_amdhsa_kernel
```
